```python
import torch

def _softmax(x, axis=-1):
    return torch.softmax(x, dim=axis)

def _gelu(x):
    return torch.nn.functional.gelu(x, approximate='tanh')

def _silu(x):
    return torch.nn.functional.silu(x)

def _sigmoid(x):
    return torch.sigmoid(x)

def _layernorm(x, axis=-1, eps=1e-05):
    m = x.mean(dim=axis, keepdim=True)
    v = x.var(dim=axis, keepdim=True, unbiased=False)
    return (x - m) / torch.sqrt(v + eps)

def _scatter_add(tgt, idx, src, axis=0):
    return tgt.clone().index_add_(axis, idx, src)

def _segment_sum(src, seg, n):
    out = torch.zeros((n,) + src.shape[1:], dtype=src.dtype)
    return out.index_add_(0, seg, src)

def _pad(x, pw):
    flat = tuple((v for pair in reversed(pw) for v in pair))
    return torch.nn.functional.pad(x, flat)
kernel_name = 'adaLN_cond__gqa_block_cached__geglu_ffn__decode'

def setup_inputs():

    _w = lambda a: (lambda t: t.to(torch.bfloat16) if t.is_floating_point() else t)(torch.as_tensor(a))

    def _A_setup():
        B, Sq, D = (1, 1, 1024)
        Hq, Hkv, Sk, Dh = (32, 4, 65536, 128)
        assert Hq % Hkv == 0, (Hq, Hkv)
        return {'x': _w((lambda *s: torch.randn(*s, dtype=torch.bfloat16) * 0.05)(B, Sq, D)), 'k_cache': _w((lambda *s: torch.randn(*s, dtype=torch.bfloat16) * 3.2)(B, Hkv, Sk, Dh)), 'v_cache': _w((lambda *s: torch.randn(*s, dtype=torch.bfloat16) * 0.4)(B, Hkv, Sk, Dh)), 'wq': _w((lambda *s: torch.randn(*s, dtype=torch.bfloat16) * 3.2)(D, Hq * Dh) * D ** (-0.5)), 'wo': _w((lambda *s: torch.randn(*s, dtype=torch.bfloat16) * 0.4)(Hq * Dh, D) * (Hq * Dh) ** (-0.5))}
    _A_in = _A_setup()

    def _B_setup():
        B, S, D, F = (1, 1, 1024, 3584)
        return {'x': _w((lambda *s: torch.randn(*s, dtype=torch.bfloat16) * 0.05)(B, S, D)), 'w_gate': _w((lambda *s: torch.randn(*s, dtype=torch.bfloat16) * 0.05)(D, F)), 'w_up': _w((lambda *s: torch.randn(*s, dtype=torch.bfloat16) * 0.05)(D, F)), 'w_down': _w((lambda *s: torch.randn(*s, dtype=torch.bfloat16) * 0.05)(F, D))}
    _B_in = _B_setup()
    return {'A_x': _A_in['x'], 'A_k_cache': _A_in['k_cache'], 'A_v_cache': _A_in['v_cache'], 'A_wq': _A_in['wq'], 'A_wo': _A_in['wo'], 'B_x': _B_in['x'], 'B_w_gate': _B_in['w_gate'], 'B_w_up': _B_in['w_up'], 'B_w_down': _B_in['w_down'], 'c': _w((lambda *s: torch.randn(*s, dtype=torch.bfloat16) * 0.4)(1, 1024) * 8.0), 'w_mod': _w((lambda *s: torch.randn(*s, dtype=torch.bfloat16) * 0.4)(1024, 6 * 1024) * 1024 ** (-0.5) * 8.0)}

def reference(A_x, A_k_cache, A_v_cache, A_wq, A_wo, B_x, B_w_gate, B_w_up, B_w_down, c, w_mod):

    def _A_ref(x, k_cache, v_cache, wq, wo):
        B, Sq, D = x.shape
        Hq, Dh = (32, 128)
        Hkv = k_cache.shape[1]
        rep = Hq // Hkv
        q = (lambda x, *d: x.permute(*d))((x @ wq).reshape(B, Sq, Hq, Dh), 0, 2, 1, 3)
        k = (lambda x, n, axis: torch.repeat_interleave(x, n, dim=axis))(k_cache, rep, axis=1)
        v = (lambda x, n, axis: torch.repeat_interleave(x, n, dim=axis))(v_cache, rep, axis=1)
        scores = torch.einsum('bhqd,bhkd->bhqk', q, k) * Dh ** (-0.5)
        p = _softmax(scores, axis=-1)
        o = torch.einsum('bhqk,bhkd->bhqd', p, v)
        return (lambda x, *d: x.permute(*d))(o, 0, 2, 1, 3).reshape(B, Sq, Hq * Dh) @ wo

    def _B_ref(x, w_gate, w_up, w_down):
        return _gelu(x @ w_gate) * (x @ w_up) @ w_down
    x = A_x
    mod = (_silu(c) @ w_mod).reshape(c.shape[0], 6, 1, -1)
    sa, ca, ga, sb, cb, gb = (mod[:, 0].clone(), mod[:, 1].clone(), mod[:, 2].clone(), mod[:, 3].clone(), mod[:, 4].clone(), mod[:, 5].clone())
    h = _layernorm(x, axis=-1) * (1 + ca) + sa
    x = x + ga * _A_ref(h, A_k_cache, A_v_cache, A_wq, A_wo)
    h = _layernorm(x, axis=-1) * (1 + cb) + sb
    x = x + gb * _B_ref(h, B_w_gate, B_w_up, B_w_down)
    return x
```

```asm
; @launch kernel=k1_mod_kernel grid=(192,1,1) block=(512,1,1) lds=20480
; @launch kernel=k2_q_kernel grid=(256,1,1) block=(512,1,1) lds=24576
; @launch kernel=k3_attn_kernel grid=(256,1,1) block=(512,1,1) lds=33280
; @launch kernel=k4_wo_kernel grid=(256,1,1) block=(512,1,1) lds=36864
; @launch kernel=k5_gu_kernel grid=(224,1,1) block=(512,1,1) lds=40960
; @launch kernel=k6_down_kernel grid=(256,1,1) block=(512,1,1) lds=24576
; @launch kernel=k7_out_kernel grid=(1,1,1) block=(512,1,1) lds=0
.amdgcn_target "amdgcn-amd-amdhsa--gfx950"
.text
.p2align 8
.globl k1_mod_kernel
.type k1_mod_kernel,@function
k1_mod_kernel:
    s_cmp_ge_u32 s2, 192
    s_cbranch_scc1 k1_mod_kernel_end
    s_load_dwordx2 s[4:5], s[0:1], 72
    s_load_dwordx2 s[6:7], s[0:1], 80
    s_load_dwordx2 s[8:9], s[0:1], 104
    s_waitcnt lgkmcnt(0)
    s_mov_b32 s12, s4
    s_mov_b32 s13, s5
    s_mov_b32 s14, 2048
    s_mov_b32 s15, 0x00020000
    s_mov_b32 s16, s6
    s_mov_b32 s17, s7
    s_mov_b32 s18, 12582912
    s_mov_b32 s19, 0x00020000
    s_mov_b32 s20, s8
    s_mov_b32 s21, s9
    s_mov_b32 s22, 268435456
    s_mov_b32 s23, 0x00020000
    v_lshlrev_b32 v1, 2, v0
    buffer_load_dword v10, v1, s[12:15], 0 offen
    s_lshl_b32 s24, s2, 6
    s_mov_b32 s25, 0
    v_and_b32 v2, 3, v0
    v_lshrrev_b32 v3, 2, v0
    v_add_u32 v4, s25, v3
    s_mov_b32 s90, 12288
    v_mul_lo_u32 v5, v4, s90
    v_lshlrev_b32 v6, 4, v2
    v_add3_u32 v5, v5, v6, s24
    s_mov_b32 s91, 0
    buffer_load_dwordx4 v[64:67], v5, s[16:19], s91 offen
    s_mov_b32 s91, 1572864
    buffer_load_dwordx4 v[68:71], v5, s[16:19], s91 offen
    s_mov_b32 s91, 3145728
    buffer_load_dwordx4 v[72:75], v5, s[16:19], s91 offen
    s_mov_b32 s91, 4718592
    buffer_load_dwordx4 v[76:79], v5, s[16:19], s91 offen
    s_mov_b32 s91, 6291456
    buffer_load_dwordx4 v[80:83], v5, s[16:19], s91 offen
    s_mov_b32 s91, 7864320
    buffer_load_dwordx4 v[84:87], v5, s[16:19], s91 offen
    s_mov_b32 s91, 9437184
    buffer_load_dwordx4 v[88:91], v5, s[16:19], s91 offen
    s_mov_b32 s91, 11010048
    buffer_load_dwordx4 v[92:95], v5, s[16:19], s91 offen
    s_cmp_ge_u32 s2, 3
    s_cbranch_scc1 k1_mod_kernel_nz
    v_mov_b32 v12, 0
    v_mov_b32 v13, 0
    v_mov_b32 v14, 0
    v_mov_b32 v15, 0
    s_lshl_b32 s26, s2, 13
    s_add_u32 s26, s26, 32768
    v_lshlrev_b32 v11, 4, v0
    buffer_store_dwordx4 v[12:15], v11, s[20:23], s26 offen
k1_mod_kernel_nz:
    s_waitcnt vmcnt(8)
    v_lshlrev_b32 v12, 16, v10
    v_and_b32 v13, 0xffff0000, v10
    v_mul_f32 v14, 0xbfb8aa3b, v12
    v_exp_f32 v14, v14
    s_nop 0
    v_add_f32 v14, 1.0, v14
    v_rcp_f32 v14, v14
    s_nop 0
    v_mul_f32 v12, v12, v14
    v_cvt_pk_bf16_f32 v14, v12, v12
    v_lshlrev_b32 v12, 16, v14
    v_mul_f32 v14, 0xbfb8aa3b, v13
    v_exp_f32 v14, v14
    s_nop 0
    v_add_f32 v14, 1.0, v14
    v_rcp_f32 v14, v14
    s_nop 0
    v_mul_f32 v13, v13, v14
    v_cvt_pk_bf16_f32 v14, v13, v13
    v_lshlrev_b32 v13, 16, v14
    v_lshlrev_b32 v14, 3, v0
    ds_write_b64 v14, v[12:13]
    s_waitcnt lgkmcnt(0)
    s_barrier
    v_lshlrev_b32 v7, 2, v4
    ds_read_b32 v16, v7 offset:0
    ds_read_b32 v17, v7 offset:512
    ds_read_b32 v18, v7 offset:1024
    ds_read_b32 v19, v7 offset:1536
    ds_read_b32 v20, v7 offset:2048
    ds_read_b32 v21, v7 offset:2560
    ds_read_b32 v22, v7 offset:3072
    ds_read_b32 v23, v7 offset:3584
    v_mov_b32 v32, 0
    v_mov_b32 v33, 0
    v_mov_b32 v34, 0
    v_mov_b32 v35, 0
    v_mov_b32 v36, 0
    v_mov_b32 v37, 0
    v_mov_b32 v38, 0
    v_mov_b32 v39, 0
    s_waitcnt vmcnt(0) lgkmcnt(0)
    v_lshlrev_b32 v8, 16, v64
    v_and_b32 v9, 0xffff0000, v64
    v_fmac_f32 v32, v16, v8
    v_fmac_f32 v33, v16, v9
    v_lshlrev_b32 v8, 16, v65
    v_and_b32 v9, 0xffff0000, v65
    v_fmac_f32 v34, v16, v8
    v_fmac_f32 v35, v16, v9
    v_lshlrev_b32 v8, 16, v66
    v_and_b32 v9, 0xffff0000, v66
    v_fmac_f32 v36, v16, v8
    v_fmac_f32 v37, v16, v9
    v_lshlrev_b32 v8, 16, v67
    v_and_b32 v9, 0xffff0000, v67
    v_fmac_f32 v38, v16, v8
    v_fmac_f32 v39, v16, v9
    v_lshlrev_b32 v8, 16, v68
    v_and_b32 v9, 0xffff0000, v68
    v_fmac_f32 v32, v17, v8
    v_fmac_f32 v33, v17, v9
    v_lshlrev_b32 v8, 16, v69
    v_and_b32 v9, 0xffff0000, v69
    v_fmac_f32 v34, v17, v8
    v_fmac_f32 v35, v17, v9
    v_lshlrev_b32 v8, 16, v70
    v_and_b32 v9, 0xffff0000, v70
    v_fmac_f32 v36, v17, v8
    v_fmac_f32 v37, v17, v9
    v_lshlrev_b32 v8, 16, v71
    v_and_b32 v9, 0xffff0000, v71
    v_fmac_f32 v38, v17, v8
    v_fmac_f32 v39, v17, v9
    v_lshlrev_b32 v8, 16, v72
    v_and_b32 v9, 0xffff0000, v72
    v_fmac_f32 v32, v18, v8
    v_fmac_f32 v33, v18, v9
    v_lshlrev_b32 v8, 16, v73
    v_and_b32 v9, 0xffff0000, v73
    v_fmac_f32 v34, v18, v8
    v_fmac_f32 v35, v18, v9
    v_lshlrev_b32 v8, 16, v74
    v_and_b32 v9, 0xffff0000, v74
    v_fmac_f32 v36, v18, v8
    v_fmac_f32 v37, v18, v9
    v_lshlrev_b32 v8, 16, v75
    v_and_b32 v9, 0xffff0000, v75
    v_fmac_f32 v38, v18, v8
    v_fmac_f32 v39, v18, v9
    v_lshlrev_b32 v8, 16, v76
    v_and_b32 v9, 0xffff0000, v76
    v_fmac_f32 v32, v19, v8
    v_fmac_f32 v33, v19, v9
    v_lshlrev_b32 v8, 16, v77
    v_and_b32 v9, 0xffff0000, v77
    v_fmac_f32 v34, v19, v8
    v_fmac_f32 v35, v19, v9
    v_lshlrev_b32 v8, 16, v78
    v_and_b32 v9, 0xffff0000, v78
    v_fmac_f32 v36, v19, v8
    v_fmac_f32 v37, v19, v9
    v_lshlrev_b32 v8, 16, v79
    v_and_b32 v9, 0xffff0000, v79
    v_fmac_f32 v38, v19, v8
    v_fmac_f32 v39, v19, v9
    v_lshlrev_b32 v8, 16, v80
    v_and_b32 v9, 0xffff0000, v80
    v_fmac_f32 v32, v20, v8
    v_fmac_f32 v33, v20, v9
    v_lshlrev_b32 v8, 16, v81
    v_and_b32 v9, 0xffff0000, v81
    v_fmac_f32 v34, v20, v8
    v_fmac_f32 v35, v20, v9
    v_lshlrev_b32 v8, 16, v82
    v_and_b32 v9, 0xffff0000, v82
    v_fmac_f32 v36, v20, v8
    v_fmac_f32 v37, v20, v9
    v_lshlrev_b32 v8, 16, v83
    v_and_b32 v9, 0xffff0000, v83
    v_fmac_f32 v38, v20, v8
    v_fmac_f32 v39, v20, v9
    v_lshlrev_b32 v8, 16, v84
    v_and_b32 v9, 0xffff0000, v84
    v_fmac_f32 v32, v21, v8
    v_fmac_f32 v33, v21, v9
    v_lshlrev_b32 v8, 16, v85
    v_and_b32 v9, 0xffff0000, v85
    v_fmac_f32 v34, v21, v8
    v_fmac_f32 v35, v21, v9
    v_lshlrev_b32 v8, 16, v86
    v_and_b32 v9, 0xffff0000, v86
    v_fmac_f32 v36, v21, v8
    v_fmac_f32 v37, v21, v9
    v_lshlrev_b32 v8, 16, v87
    v_and_b32 v9, 0xffff0000, v87
    v_fmac_f32 v38, v21, v8
    v_fmac_f32 v39, v21, v9
    v_lshlrev_b32 v8, 16, v88
    v_and_b32 v9, 0xffff0000, v88
    v_fmac_f32 v32, v22, v8
    v_fmac_f32 v33, v22, v9
    v_lshlrev_b32 v8, 16, v89
    v_and_b32 v9, 0xffff0000, v89
    v_fmac_f32 v34, v22, v8
    v_fmac_f32 v35, v22, v9
    v_lshlrev_b32 v8, 16, v90
    v_and_b32 v9, 0xffff0000, v90
    v_fmac_f32 v36, v22, v8
    v_fmac_f32 v37, v22, v9
    v_lshlrev_b32 v8, 16, v91
    v_and_b32 v9, 0xffff0000, v91
    v_fmac_f32 v38, v22, v8
    v_fmac_f32 v39, v22, v9
    v_lshlrev_b32 v8, 16, v92
    v_and_b32 v9, 0xffff0000, v92
    v_fmac_f32 v32, v23, v8
    v_fmac_f32 v33, v23, v9
    v_lshlrev_b32 v8, 16, v93
    v_and_b32 v9, 0xffff0000, v93
    v_fmac_f32 v34, v23, v8
    v_fmac_f32 v35, v23, v9
    v_lshlrev_b32 v8, 16, v94
    v_and_b32 v9, 0xffff0000, v94
    v_fmac_f32 v36, v23, v8
    v_fmac_f32 v37, v23, v9
    v_lshlrev_b32 v8, 16, v95
    v_and_b32 v9, 0xffff0000, v95
    v_fmac_f32 v38, v23, v8
    v_fmac_f32 v39, v23, v9
    v_lshlrev_b32 v7, 5, v0
    ds_write_b128 v7, v[32:35] offset:4096
    ds_write_b128 v7, v[36:39] offset:4112
    s_waitcnt lgkmcnt(0)
    s_barrier
    v_and_b32 v10, 31, v0
    v_lshrrev_b32 v11, 5, v0
    v_mul_u32_u24 v12, 1024, v11
    v_lshl_add_u32 v12, v10, 2, v12
    ds_read_b32 v16, v12 offset:4096
    ds_read_b32 v17, v12 offset:4224
    ds_read_b32 v18, v12 offset:4352
    ds_read_b32 v19, v12 offset:4480
    ds_read_b32 v20, v12 offset:4608
    ds_read_b32 v21, v12 offset:4736
    ds_read_b32 v22, v12 offset:4864
    ds_read_b32 v23, v12 offset:4992
    s_waitcnt lgkmcnt(0)
    v_add_f32 v16, v16, v17
    v_add_f32 v16, v16, v18
    v_add_f32 v16, v16, v19
    v_add_f32 v16, v16, v20
    v_add_f32 v16, v16, v21
    v_add_f32 v16, v16, v22
    v_add_f32 v16, v16, v23
    v_mov_b32 v48, v16
    s_barrier
    v_lshlrev_b32 v12, 2, v0
    ds_write_b32 v12, v48 offset:4096
    s_waitcnt lgkmcnt(0)
    s_barrier
    v_lshlrev_b32 v12, 2, v10
    ds_read_b32 v16, v12 offset:4096
    ds_read_b32 v17, v12 offset:4224
    ds_read_b32 v18, v12 offset:4352
    ds_read_b32 v19, v12 offset:4480
    ds_read_b32 v20, v12 offset:4608
    ds_read_b32 v21, v12 offset:4736
    ds_read_b32 v22, v12 offset:4864
    ds_read_b32 v23, v12 offset:4992
    ds_read_b32 v24, v12 offset:5120
    ds_read_b32 v25, v12 offset:5248
    ds_read_b32 v26, v12 offset:5376
    ds_read_b32 v27, v12 offset:5504
    ds_read_b32 v28, v12 offset:5632
    ds_read_b32 v29, v12 offset:5760
    ds_read_b32 v30, v12 offset:5888
    ds_read_b32 v31, v12 offset:6016
    s_waitcnt lgkmcnt(0)
    v_add_f32 v16, v16, v17
    v_add_f32 v16, v16, v18
    v_add_f32 v16, v16, v19
    v_add_f32 v16, v16, v20
    v_add_f32 v16, v16, v21
    v_add_f32 v16, v16, v22
    v_add_f32 v16, v16, v23
    v_add_f32 v16, v16, v24
    v_add_f32 v16, v16, v25
    v_add_f32 v16, v16, v26
    v_add_f32 v16, v16, v27
    v_add_f32 v16, v16, v28
    v_add_f32 v16, v16, v29
    v_add_f32 v16, v16, v30
    v_add_f32 v16, v16, v31
    v_mov_b32 v50, v16
    v_cvt_pk_bf16_f32 v51, v50, v50
    v_lshlrev_b32 v50, 16, v51
    v_cmp_gt_u32 vcc, 32, v0
    s_and_saveexec_b64 s[30:31], vcc
    v_lshlrev_b32 v11, 2, v0
    s_lshl_b32 s26, s2, 7
    buffer_store_dword v50, v11, s[20:23], s26 offen offset:0
k1_mod_kernel_end:
    s_endpgm
.p2align 8
.globl k2_q_kernel
.type k2_q_kernel,@function
k2_q_kernel:
    s_cmp_ge_u32 s2, 256
    s_cbranch_scc1 k2_q_kernel_end
    s_load_dwordx2 s[4:5], s[0:1], 0
    s_load_dwordx2 s[6:7], s[0:1], 24
    s_load_dwordx2 s[8:9], s[0:1], 104
    s_waitcnt lgkmcnt(0)
    s_mov_b32 s12, s4
    s_mov_b32 s13, s5
    s_mov_b32 s14, 2048
    s_mov_b32 s15, 0x00020000
    s_mov_b32 s16, s6
    s_mov_b32 s17, s7
    s_mov_b32 s18, 8388608
    s_mov_b32 s19, 0x00020000
    s_mov_b32 s20, s8
    s_mov_b32 s21, s9
    s_mov_b32 s22, 268435456
    s_mov_b32 s23, 0x00020000
    v_lshlrev_b32 v1, 2, v0
    buffer_load_dword v10, v1, s[12:15], 0 offen
    s_and_b32 s26, s2, 63
    s_lshl_b32 s24, s26, 7
    s_lshr_b32 s25, s2, 6
    s_lshl_b32 s25, s25, 8
    v_and_b32 v2, 7, v0
    v_lshrrev_b32 v3, 3, v0
    v_add_u32 v4, s25, v3
    s_mov_b32 s90, 8192
    v_mul_lo_u32 v5, v4, s90
    v_lshlrev_b32 v6, 4, v2
    v_add3_u32 v5, v5, v6, s24
    s_mov_b32 s91, 0
    buffer_load_dwordx4 v[64:67], v5, s[16:19], s91 offen
    s_mov_b32 s91, 524288
    buffer_load_dwordx4 v[68:71], v5, s[16:19], s91 offen
    s_mov_b32 s91, 1048576
    buffer_load_dwordx4 v[72:75], v5, s[16:19], s91 offen
    s_mov_b32 s91, 1572864
    buffer_load_dwordx4 v[76:79], v5, s[16:19], s91 offen
    s_waitcnt vmcnt(4)
    v_lshlrev_b32 v12, 16, v10
    v_and_b32 v13, 0xffff0000, v10
    v_lshlrev_b32 v20, 3, v0
    s_mov_b32 s92, 0
    s_mov_b32 s93, 4096
    buffer_load_dwordx2 v[22:23], v20, s[20:23], s92 offen
    buffer_load_dwordx2 v[24:25], v20, s[20:23], s93 offen
    v_add_f32 v26, v12, v13
    ds_swizzle_b32 v30, v26 offset:0x41f
    s_waitcnt lgkmcnt(0)
    v_add_f32 v26, v26, v30
    ds_swizzle_b32 v30, v26 offset:0x81f
    s_waitcnt lgkmcnt(0)
    v_add_f32 v26, v26, v30
    ds_swizzle_b32 v30, v26 offset:0x101f
    s_waitcnt lgkmcnt(0)
    v_add_f32 v26, v26, v30
    ds_swizzle_b32 v30, v26 offset:0x201f
    s_waitcnt lgkmcnt(0)
    v_add_f32 v26, v26, v30
    ds_swizzle_b32 v30, v26 offset:0x401f
    s_waitcnt lgkmcnt(0)
    v_add_f32 v26, v26, v30
    v_mov_b32 v30, v26
    s_nop 1
    v_permlane32_swap_b32 v30, v26
    s_nop 1
    v_add_f32 v26, v26, v30
    v_lshrrev_b32 v30, 6, v0
    v_lshlrev_b32 v30, 2, v30
    ds_write_b32 v30, v26 offset:4096
    s_waitcnt lgkmcnt(0)
    s_barrier
    v_mov_b32 v30, 0
    ds_read_b128 v[32:35], v30 offset:4096
    ds_read_b128 v[36:39], v30 offset:4112
    s_waitcnt lgkmcnt(0)
    v_add_f32 v26, v32, v33
    v_add_f32 v26, v26, v34
    v_add_f32 v26, v26, v35
    v_add_f32 v26, v26, v36
    v_add_f32 v26, v26, v37
    v_add_f32 v26, v26, v38
    v_add_f32 v26, v26, v39
    s_barrier
    v_mul_f32 v26, 0x3a800000, v26
    v_sub_f32 v27, v12, v26
    v_sub_f32 v28, v13, v26
    v_mul_f32 v27, v27, v27
    v_fmac_f32 v27, v28, v28
    ds_swizzle_b32 v30, v27 offset:0x41f
    s_waitcnt lgkmcnt(0)
    v_add_f32 v27, v27, v30
    ds_swizzle_b32 v30, v27 offset:0x81f
    s_waitcnt lgkmcnt(0)
    v_add_f32 v27, v27, v30
    ds_swizzle_b32 v30, v27 offset:0x101f
    s_waitcnt lgkmcnt(0)
    v_add_f32 v27, v27, v30
    ds_swizzle_b32 v30, v27 offset:0x201f
    s_waitcnt lgkmcnt(0)
    v_add_f32 v27, v27, v30
    ds_swizzle_b32 v30, v27 offset:0x401f
    s_waitcnt lgkmcnt(0)
    v_add_f32 v27, v27, v30
    v_mov_b32 v30, v27
    s_nop 1
    v_permlane32_swap_b32 v30, v27
    s_nop 1
    v_add_f32 v27, v27, v30
    v_lshrrev_b32 v30, 6, v0
    v_lshlrev_b32 v30, 2, v30
    ds_write_b32 v30, v27 offset:4096
    s_waitcnt lgkmcnt(0)
    s_barrier
    v_mov_b32 v30, 0
    ds_read_b128 v[32:35], v30 offset:4096
    ds_read_b128 v[36:39], v30 offset:4112
    s_waitcnt lgkmcnt(0)
    v_add_f32 v27, v32, v33
    v_add_f32 v27, v27, v34
    v_add_f32 v27, v27, v35
    v_add_f32 v27, v27, v36
    v_add_f32 v27, v27, v37
    v_add_f32 v27, v27, v38
    v_add_f32 v27, v27, v39
    s_barrier
    v_mul_f32 v27, 0x3a800000, v27
    v_cvt_pk_bf16_f32 v30, v27, v27
    v_lshlrev_b32 v27, 16, v30
    v_cvt_pk_bf16_f32 v30, v26, v26
    v_lshlrev_b32 v26, 16, v30
    v_add_f32 v27, 0x3727c5ac, v27
    v_cvt_pk_bf16_f32 v30, v27, v27
    v_lshlrev_b32 v27, 16, v30
    v_sqrt_f32 v27, v27
    s_nop 0
    v_cvt_pk_bf16_f32 v30, v27, v27
    v_lshlrev_b32 v27, 16, v30
    v_rcp_f32 v27, v27
    s_waitcnt vmcnt(0)
    v_sub_f32 v28, v12, v26
    v_cvt_pk_bf16_f32 v30, v28, v28
    v_lshlrev_b32 v28, 16, v30
    v_mul_f32 v28, v28, v27
    v_cvt_pk_bf16_f32 v30, v28, v28
    v_lshlrev_b32 v28, 16, v30
    v_add_f32 v29, 1.0, v24
    v_cvt_pk_bf16_f32 v30, v29, v29
    v_lshlrev_b32 v29, 16, v30
    v_mul_f32 v28, v28, v29
    v_cvt_pk_bf16_f32 v30, v28, v28
    v_lshlrev_b32 v28, 16, v30
    v_add_f32 v40, v28, v22
    v_cvt_pk_bf16_f32 v30, v40, v40
    v_lshlrev_b32 v40, 16, v30
    v_sub_f32 v28, v13, v26
    v_cvt_pk_bf16_f32 v30, v28, v28
    v_lshlrev_b32 v28, 16, v30
    v_mul_f32 v28, v28, v27
    v_cvt_pk_bf16_f32 v30, v28, v28
    v_lshlrev_b32 v28, 16, v30
    v_add_f32 v29, 1.0, v25
    v_cvt_pk_bf16_f32 v30, v29, v29
    v_lshlrev_b32 v29, 16, v30
    v_mul_f32 v28, v28, v29
    v_cvt_pk_bf16_f32 v30, v28, v28
    v_lshlrev_b32 v28, 16, v30
    v_add_f32 v41, v28, v23
    v_cvt_pk_bf16_f32 v30, v41, v41
    v_lshlrev_b32 v41, 16, v30
    v_lshlrev_b32 v20, 3, v0
    ds_write_b64 v20, v[40:41] offset:0
    s_waitcnt lgkmcnt(0)
    s_barrier
    v_lshlrev_b32 v7, 2, v4
    ds_read_b32 v16, v7 offset:0
    ds_read_b32 v17, v7 offset:256
    ds_read_b32 v18, v7 offset:512
    ds_read_b32 v19, v7 offset:768
    v_mov_b32 v32, 0
    v_mov_b32 v33, 0
    v_mov_b32 v34, 0
    v_mov_b32 v35, 0
    v_mov_b32 v36, 0
    v_mov_b32 v37, 0
    v_mov_b32 v38, 0
    v_mov_b32 v39, 0
    s_waitcnt vmcnt(0) lgkmcnt(0)
    v_lshlrev_b32 v8, 16, v64
    v_and_b32 v9, 0xffff0000, v64
    v_fmac_f32 v32, v16, v8
    v_fmac_f32 v33, v16, v9
    v_lshlrev_b32 v8, 16, v65
    v_and_b32 v9, 0xffff0000, v65
    v_fmac_f32 v34, v16, v8
    v_fmac_f32 v35, v16, v9
    v_lshlrev_b32 v8, 16, v66
    v_and_b32 v9, 0xffff0000, v66
    v_fmac_f32 v36, v16, v8
    v_fmac_f32 v37, v16, v9
    v_lshlrev_b32 v8, 16, v67
    v_and_b32 v9, 0xffff0000, v67
    v_fmac_f32 v38, v16, v8
    v_fmac_f32 v39, v16, v9
    v_lshlrev_b32 v8, 16, v68
    v_and_b32 v9, 0xffff0000, v68
    v_fmac_f32 v32, v17, v8
    v_fmac_f32 v33, v17, v9
    v_lshlrev_b32 v8, 16, v69
    v_and_b32 v9, 0xffff0000, v69
    v_fmac_f32 v34, v17, v8
    v_fmac_f32 v35, v17, v9
    v_lshlrev_b32 v8, 16, v70
    v_and_b32 v9, 0xffff0000, v70
    v_fmac_f32 v36, v17, v8
    v_fmac_f32 v37, v17, v9
    v_lshlrev_b32 v8, 16, v71
    v_and_b32 v9, 0xffff0000, v71
    v_fmac_f32 v38, v17, v8
    v_fmac_f32 v39, v17, v9
    v_lshlrev_b32 v8, 16, v72
    v_and_b32 v9, 0xffff0000, v72
    v_fmac_f32 v32, v18, v8
    v_fmac_f32 v33, v18, v9
    v_lshlrev_b32 v8, 16, v73
    v_and_b32 v9, 0xffff0000, v73
    v_fmac_f32 v34, v18, v8
    v_fmac_f32 v35, v18, v9
    v_lshlrev_b32 v8, 16, v74
    v_and_b32 v9, 0xffff0000, v74
    v_fmac_f32 v36, v18, v8
    v_fmac_f32 v37, v18, v9
    v_lshlrev_b32 v8, 16, v75
    v_and_b32 v9, 0xffff0000, v75
    v_fmac_f32 v38, v18, v8
    v_fmac_f32 v39, v18, v9
    v_lshlrev_b32 v8, 16, v76
    v_and_b32 v9, 0xffff0000, v76
    v_fmac_f32 v32, v19, v8
    v_fmac_f32 v33, v19, v9
    v_lshlrev_b32 v8, 16, v77
    v_and_b32 v9, 0xffff0000, v77
    v_fmac_f32 v34, v19, v8
    v_fmac_f32 v35, v19, v9
    v_lshlrev_b32 v8, 16, v78
    v_and_b32 v9, 0xffff0000, v78
    v_fmac_f32 v36, v19, v8
    v_fmac_f32 v37, v19, v9
    v_lshlrev_b32 v8, 16, v79
    v_and_b32 v9, 0xffff0000, v79
    v_fmac_f32 v38, v19, v8
    v_fmac_f32 v39, v19, v9
    v_lshlrev_b32 v7, 5, v0
    ds_write_b128 v7, v[32:35] offset:8192
    ds_write_b128 v7, v[36:39] offset:8208
    s_waitcnt lgkmcnt(0)
    s_barrier
    v_and_b32 v10, 63, v0
    v_lshrrev_b32 v11, 6, v0
    v_mul_u32_u24 v12, 2048, v11
    v_lshl_add_u32 v12, v10, 2, v12
    ds_read_b32 v16, v12 offset:8192
    ds_read_b32 v17, v12 offset:8448
    ds_read_b32 v18, v12 offset:8704
    ds_read_b32 v19, v12 offset:8960
    ds_read_b32 v20, v12 offset:9216
    ds_read_b32 v21, v12 offset:9472
    ds_read_b32 v22, v12 offset:9728
    ds_read_b32 v23, v12 offset:9984
    s_waitcnt lgkmcnt(0)
    v_add_f32 v16, v16, v17
    v_add_f32 v16, v16, v18
    v_add_f32 v16, v16, v19
    v_add_f32 v16, v16, v20
    v_add_f32 v16, v16, v21
    v_add_f32 v16, v16, v22
    v_add_f32 v16, v16, v23
    v_mov_b32 v48, v16
    s_barrier
    v_lshlrev_b32 v12, 2, v0
    ds_write_b32 v12, v48 offset:8192
    s_waitcnt lgkmcnt(0)
    s_barrier
    v_lshlrev_b32 v12, 2, v10
    ds_read_b32 v16, v12 offset:8192
    ds_read_b32 v17, v12 offset:8448
    ds_read_b32 v18, v12 offset:8704
    ds_read_b32 v19, v12 offset:8960
    ds_read_b32 v20, v12 offset:9216
    ds_read_b32 v21, v12 offset:9472
    ds_read_b32 v22, v12 offset:9728
    ds_read_b32 v23, v12 offset:9984
    s_waitcnt lgkmcnt(0)
    v_add_f32 v16, v16, v17
    v_add_f32 v16, v16, v18
    v_add_f32 v16, v16, v19
    v_add_f32 v16, v16, v20
    v_add_f32 v16, v16, v21
    v_add_f32 v16, v16, v22
    v_add_f32 v16, v16, v23
    v_mov_b32 v50, v16
    v_cmp_gt_u32 vcc, 64, v0
    s_and_saveexec_b64 s[30:31], vcc
    v_lshlrev_b32 v11, 2, v0
    s_lshl_b32 s27, s26, 8
    s_add_u32 s27, s27, 32768
    v_add_u32 v11, s27, v11
    global_atomic_add_f32 v11, v50, s[8:9]
k2_q_kernel_end:
    s_endpgm
.p2align 8
.globl k3_attn_kernel
.type k3_attn_kernel,@function
k3_attn_kernel:
    s_cmp_ge_u32 s2, 256
    s_cbranch_scc1 k3_attn_kernel_end
    s_load_dwordx2 s[4:5], s[0:1], 8
    s_load_dwordx2 s[6:7], s[0:1], 16
    s_load_dwordx2 s[8:9], s[0:1], 104
    s_waitcnt lgkmcnt(0)
    s_mov_b32 s12, s4
    s_mov_b32 s13, s5
    s_mov_b32 s14, 67108864
    s_mov_b32 s15, 0x00020000
    s_mov_b32 s16, s6
    s_mov_b32 s17, s7
    s_mov_b32 s18, 67108864
    s_mov_b32 s19, 0x00020000
    s_mov_b32 s20, s8
    s_mov_b32 s21, s9
    s_mov_b32 s22, 268435456
    s_mov_b32 s23, 0x00020000
    s_lshr_b32 s24, s2, 6
    s_and_b32 s25, s2, 63
    v_lshrrev_b32 v1, 6, v0
    v_and_b32 v2, 63, v0
    v_and_b32 v3, 15, v2
    v_lshrrev_b32 v4, 4, v2
    s_lshl_b32 s26, s24, 24
    s_lshl_b32 s27, s25, 18
    s_add_u32 s26, s26, s27
    v_lshlrev_b32 v5, 15, v1
    v_add_u32 v5, s26, v5
    v_lshl_add_u32 v6, v3, 8, v5
    v_lshl_add_u32 v6, v4, 4, v6
    v_lshl_add_u32 v7, v4, 10, v5
    v_lshl_add_u32 v7, v3, 4, v7
    v_and_b32 v8, 7, v3
    s_lshl_b32 s28, s24, 12
    v_lshlrev_b32 v8, 9, v8
    v_lshl_add_u32 v8, v4, 5, v8
    s_add_u32 s28, s28, 32768
    buffer_load_dwordx4 v[224:227], v8, s[20:23], s28 offen offset:0
    buffer_load_dwordx4 v[228:231], v8, s[20:23], s28 offen offset:16
    buffer_load_dwordx4 v[232:235], v8, s[20:23], s28 offen offset:128
    buffer_load_dwordx4 v[236:239], v8, s[20:23], s28 offen offset:144
    buffer_load_dwordx4 v[240:243], v8, s[20:23], s28 offen offset:256
    buffer_load_dwordx4 v[244:247], v8, s[20:23], s28 offen offset:272
    buffer_load_dwordx4 v[248:251], v8, s[20:23], s28 offen offset:384
    buffer_load_dwordx4 v[252:255], v8, s[20:23], s28 offen offset:400
    s_mov_b32 s29, 0
    buffer_load_dwordx4 v[64:67], v6, s[12:15], s29 offen offset:0
    buffer_load_dwordx4 v[68:71], v6, s[12:15], s29 offen offset:64
    buffer_load_dwordx4 v[72:75], v6, s[12:15], s29 offen offset:128
    buffer_load_dwordx4 v[76:79], v6, s[12:15], s29 offen offset:192
    s_mov_b32 s29, 4096
    buffer_load_dwordx4 v[80:83], v6, s[12:15], s29 offen offset:0
    buffer_load_dwordx4 v[84:87], v6, s[12:15], s29 offen offset:64
    buffer_load_dwordx4 v[88:91], v6, s[12:15], s29 offen offset:128
    buffer_load_dwordx4 v[92:95], v6, s[12:15], s29 offen offset:192
    s_mov_b32 s29, 8192
    buffer_load_dwordx4 v[96:99], v6, s[12:15], s29 offen offset:0
    buffer_load_dwordx4 v[100:103], v6, s[12:15], s29 offen offset:64
    buffer_load_dwordx4 v[104:107], v6, s[12:15], s29 offen offset:128
    buffer_load_dwordx4 v[108:111], v6, s[12:15], s29 offen offset:192
    s_mov_b32 s29, 12288
    buffer_load_dwordx4 v[112:115], v6, s[12:15], s29 offen offset:0
    buffer_load_dwordx4 v[116:119], v6, s[12:15], s29 offen offset:64
    buffer_load_dwordx4 v[120:123], v6, s[12:15], s29 offen offset:128
    buffer_load_dwordx4 v[124:127], v6, s[12:15], s29 offen offset:192
    s_mov_b32 s29, 16384
    buffer_load_dwordx4 v[128:131], v6, s[12:15], s29 offen offset:0
    buffer_load_dwordx4 v[132:135], v6, s[12:15], s29 offen offset:64
    buffer_load_dwordx4 v[136:139], v6, s[12:15], s29 offen offset:128
    buffer_load_dwordx4 v[140:143], v6, s[12:15], s29 offen offset:192
    s_mov_b32 s29, 20480
    buffer_load_dwordx4 v[144:147], v6, s[12:15], s29 offen offset:0
    buffer_load_dwordx4 v[148:151], v6, s[12:15], s29 offen offset:64
    buffer_load_dwordx4 v[152:155], v6, s[12:15], s29 offen offset:128
    buffer_load_dwordx4 v[156:159], v6, s[12:15], s29 offen offset:192
    s_mov_b32 s29, 24576
    buffer_load_dwordx4 v[160:163], v6, s[12:15], s29 offen offset:0
    buffer_load_dwordx4 v[164:167], v6, s[12:15], s29 offen offset:64
    buffer_load_dwordx4 v[168:171], v6, s[12:15], s29 offen offset:128
    buffer_load_dwordx4 v[172:175], v6, s[12:15], s29 offen offset:192
    s_mov_b32 s29, 28672
    buffer_load_dwordx4 v[176:179], v6, s[12:15], s29 offen offset:0
    buffer_load_dwordx4 v[180:183], v6, s[12:15], s29 offen offset:64
    buffer_load_dwordx4 v[184:187], v6, s[12:15], s29 offen offset:128
    buffer_load_dwordx4 v[188:191], v6, s[12:15], s29 offen offset:192
    s_mov_b32 s29, 0
    buffer_load_dwordx4 v[192:195], v7, s[16:19], s29 offen offset:0
    buffer_load_dwordx4 v[196:199], v7, s[16:19], s29 offen offset:256
    buffer_load_dwordx4 v[200:203], v7, s[16:19], s29 offen offset:512
    buffer_load_dwordx4 v[204:207], v7, s[16:19], s29 offen offset:768
    s_mov_b32 s29, 4096
    buffer_load_dwordx4 v[208:211], v7, s[16:19], s29 offen offset:0
    buffer_load_dwordx4 v[212:215], v7, s[16:19], s29 offen offset:256
    buffer_load_dwordx4 v[216:219], v7, s[16:19], s29 offen offset:512
    buffer_load_dwordx4 v[220:223], v7, s[16:19], s29 offen offset:768
    s_waitcnt vmcnt(40)
    v_cvt_pk_bf16_f32 v16, v224, v225
    v_cvt_pk_bf16_f32 v17, v226, v227
    v_cvt_pk_bf16_f32 v18, v228, v229
    v_cvt_pk_bf16_f32 v19, v230, v231
    v_cvt_pk_bf16_f32 v20, v232, v233
    v_cvt_pk_bf16_f32 v21, v234, v235
    v_cvt_pk_bf16_f32 v22, v236, v237
    v_cvt_pk_bf16_f32 v23, v238, v239
    v_cvt_pk_bf16_f32 v24, v240, v241
    v_cvt_pk_bf16_f32 v25, v242, v243
    v_cvt_pk_bf16_f32 v26, v244, v245
    v_cvt_pk_bf16_f32 v27, v246, v247
    v_cvt_pk_bf16_f32 v28, v248, v249
    v_cvt_pk_bf16_f32 v29, v250, v251
    v_cvt_pk_bf16_f32 v30, v252, v253
    v_cvt_pk_bf16_f32 v31, v254, v255
    v_mov_b32 v224, 0
    v_mov_b32 v225, 0
    v_mov_b32 v226, 0
    v_mov_b32 v227, 0
    v_mov_b32 v228, 0
    v_mov_b32 v229, 0
    v_mov_b32 v230, 0
    v_mov_b32 v231, 0
    v_mov_b32 v232, 0
    v_mov_b32 v233, 0
    v_mov_b32 v234, 0
    v_mov_b32 v235, 0
    v_mov_b32 v236, 0
    v_mov_b32 v237, 0
    v_mov_b32 v238, 0
    v_mov_b32 v239, 0
    v_mov_b32 v240, 0
    v_mov_b32 v241, 0
    v_mov_b32 v242, 0
    v_mov_b32 v243, 0
    v_mov_b32 v244, 0
    v_mov_b32 v245, 0
    v_mov_b32 v246, 0
    v_mov_b32 v247, 0
    v_mov_b32 v248, 0
    v_mov_b32 v249, 0
    v_mov_b32 v250, 0
    v_mov_b32 v251, 0
    v_mov_b32 v252, 0
    v_mov_b32 v253, 0
    v_mov_b32 v254, 0
    v_mov_b32 v255, 0
    s_waitcnt vmcnt(32)
    v_mov_b32 v32, 0
    v_mov_b32 v33, 0
    v_mov_b32 v34, 0
    v_mov_b32 v35, 0
    v_mov_b32 v36, 0
    v_mov_b32 v37, 0
    v_mov_b32 v38, 0
    v_mov_b32 v39, 0
    s_nop 1
    v_mfma_f32_16x16x32_bf16 v[32:35], v[64:67], v[16:19], v[32:35]
    v_mfma_f32_16x16x32_bf16 v[32:35], v[68:71], v[20:23], v[32:35]
    v_mfma_f32_16x16x32_bf16 v[32:35], v[72:75], v[24:27], v[32:35]
    v_mfma_f32_16x16x32_bf16 v[32:35], v[76:79], v[28:31], v[32:35]
    v_mfma_f32_16x16x32_bf16 v[36:39], v[80:83], v[16:19], v[36:39]
    v_mfma_f32_16x16x32_bf16 v[36:39], v[84:87], v[20:23], v[36:39]
    v_mfma_f32_16x16x32_bf16 v[36:39], v[88:91], v[24:27], v[36:39]
    v_mfma_f32_16x16x32_bf16 v[36:39], v[92:95], v[28:31], v[36:39]
    s_mov_b32 s29, 8192
    buffer_load_dwordx4 v[64:67], v7, s[16:19], s29 offen offset:0
    buffer_load_dwordx4 v[68:71], v7, s[16:19], s29 offen offset:256
    buffer_load_dwordx4 v[72:75], v7, s[16:19], s29 offen offset:512
    buffer_load_dwordx4 v[76:79], v7, s[16:19], s29 offen offset:768
    s_mov_b32 s29, 12288
    buffer_load_dwordx4 v[80:83], v7, s[16:19], s29 offen offset:0
    buffer_load_dwordx4 v[84:87], v7, s[16:19], s29 offen offset:256
    buffer_load_dwordx4 v[88:91], v7, s[16:19], s29 offen offset:512
    buffer_load_dwordx4 v[92:95], v7, s[16:19], s29 offen offset:768
    s_waitcnt vmcnt(32)
    v_mov_b32 v40, 0
    v_mov_b32 v41, 0
    v_mov_b32 v42, 0
    v_mov_b32 v43, 0
    v_mov_b32 v44, 0
    v_mov_b32 v45, 0
    v_mov_b32 v46, 0
    v_mov_b32 v47, 0
    s_nop 1
    v_mfma_f32_16x16x32_bf16 v[40:43], v[96:99], v[16:19], v[40:43]
    v_mfma_f32_16x16x32_bf16 v[40:43], v[100:103], v[20:23], v[40:43]
    v_mfma_f32_16x16x32_bf16 v[40:43], v[104:107], v[24:27], v[40:43]
    v_mfma_f32_16x16x32_bf16 v[40:43], v[108:111], v[28:31], v[40:43]
    v_mfma_f32_16x16x32_bf16 v[44:47], v[112:115], v[16:19], v[44:47]
    v_mfma_f32_16x16x32_bf16 v[44:47], v[116:119], v[20:23], v[44:47]
    v_mfma_f32_16x16x32_bf16 v[44:47], v[120:123], v[24:27], v[44:47]
    v_mfma_f32_16x16x32_bf16 v[44:47], v[124:127], v[28:31], v[44:47]
    s_mov_b32 s29, 16384
    buffer_load_dwordx4 v[96:99], v7, s[16:19], s29 offen offset:0
    buffer_load_dwordx4 v[100:103], v7, s[16:19], s29 offen offset:256
    buffer_load_dwordx4 v[104:107], v7, s[16:19], s29 offen offset:512
    buffer_load_dwordx4 v[108:111], v7, s[16:19], s29 offen offset:768
    s_mov_b32 s29, 20480
    buffer_load_dwordx4 v[112:115], v7, s[16:19], s29 offen offset:0
    buffer_load_dwordx4 v[116:119], v7, s[16:19], s29 offen offset:256
    buffer_load_dwordx4 v[120:123], v7, s[16:19], s29 offen offset:512
    buffer_load_dwordx4 v[124:127], v7, s[16:19], s29 offen offset:768
    s_waitcnt vmcnt(32)
    v_mov_b32 v48, 0
    v_mov_b32 v49, 0
    v_mov_b32 v50, 0
    v_mov_b32 v51, 0
    v_mov_b32 v52, 0
    v_mov_b32 v53, 0
    v_mov_b32 v54, 0
    v_mov_b32 v55, 0
    s_nop 1
    v_mfma_f32_16x16x32_bf16 v[48:51], v[128:131], v[16:19], v[48:51]
    v_mfma_f32_16x16x32_bf16 v[48:51], v[132:135], v[20:23], v[48:51]
    v_mfma_f32_16x16x32_bf16 v[48:51], v[136:139], v[24:27], v[48:51]
    v_mfma_f32_16x16x32_bf16 v[48:51], v[140:143], v[28:31], v[48:51]
    v_mfma_f32_16x16x32_bf16 v[52:55], v[144:147], v[16:19], v[52:55]
    v_mfma_f32_16x16x32_bf16 v[52:55], v[148:151], v[20:23], v[52:55]
    v_mfma_f32_16x16x32_bf16 v[52:55], v[152:155], v[24:27], v[52:55]
    v_mfma_f32_16x16x32_bf16 v[52:55], v[156:159], v[28:31], v[52:55]
    s_mov_b32 s29, 24576
    buffer_load_dwordx4 v[128:131], v7, s[16:19], s29 offen offset:0
    buffer_load_dwordx4 v[132:135], v7, s[16:19], s29 offen offset:256
    buffer_load_dwordx4 v[136:139], v7, s[16:19], s29 offen offset:512
    buffer_load_dwordx4 v[140:143], v7, s[16:19], s29 offen offset:768
    s_mov_b32 s29, 28672
    buffer_load_dwordx4 v[144:147], v7, s[16:19], s29 offen offset:0
    buffer_load_dwordx4 v[148:151], v7, s[16:19], s29 offen offset:256
    buffer_load_dwordx4 v[152:155], v7, s[16:19], s29 offen offset:512
    buffer_load_dwordx4 v[156:159], v7, s[16:19], s29 offen offset:768
    s_waitcnt vmcnt(32)
    v_mov_b32 v56, 0
    v_mov_b32 v57, 0
    v_mov_b32 v58, 0
    v_mov_b32 v59, 0
    v_mov_b32 v60, 0
    v_mov_b32 v61, 0
    v_mov_b32 v62, 0
    v_mov_b32 v63, 0
    s_nop 1
    v_mfma_f32_16x16x32_bf16 v[56:59], v[160:163], v[16:19], v[56:59]
    v_mfma_f32_16x16x32_bf16 v[56:59], v[164:167], v[20:23], v[56:59]
    v_mfma_f32_16x16x32_bf16 v[56:59], v[168:171], v[24:27], v[56:59]
    v_mfma_f32_16x16x32_bf16 v[56:59], v[172:175], v[28:31], v[56:59]
    v_mfma_f32_16x16x32_bf16 v[60:63], v[176:179], v[16:19], v[60:63]
    v_mfma_f32_16x16x32_bf16 v[60:63], v[180:183], v[20:23], v[60:63]
    v_mfma_f32_16x16x32_bf16 v[60:63], v[184:187], v[24:27], v[60:63]
    v_mfma_f32_16x16x32_bf16 v[60:63], v[188:191], v[28:31], v[60:63]
    s_nop 7
    s_nop 1
    s_mov_b32 s30, 0x3db504f3
    v_cvt_pk_bf16_f32 v8, v32, v33
    v_lshlrev_b32 v32, 16, v8
    v_and_b32 v33, 0xffff0000, v8
    v_mul_f32 v32, s30, v32
    v_mul_f32 v33, s30, v33
    v_cvt_pk_bf16_f32 v8, v32, v33
    v_lshlrev_b32 v32, 16, v8
    v_and_b32 v33, 0xffff0000, v8
    v_cvt_pk_bf16_f32 v8, v34, v35
    v_lshlrev_b32 v34, 16, v8
    v_and_b32 v35, 0xffff0000, v8
    v_mul_f32 v34, s30, v34
    v_mul_f32 v35, s30, v35
    v_cvt_pk_bf16_f32 v8, v34, v35
    v_lshlrev_b32 v34, 16, v8
    v_and_b32 v35, 0xffff0000, v8
    v_cvt_pk_bf16_f32 v8, v36, v37
    v_lshlrev_b32 v36, 16, v8
    v_and_b32 v37, 0xffff0000, v8
    v_mul_f32 v36, s30, v36
    v_mul_f32 v37, s30, v37
    v_cvt_pk_bf16_f32 v8, v36, v37
    v_lshlrev_b32 v36, 16, v8
    v_and_b32 v37, 0xffff0000, v8
    v_cvt_pk_bf16_f32 v8, v38, v39
    v_lshlrev_b32 v38, 16, v8
    v_and_b32 v39, 0xffff0000, v8
    v_mul_f32 v38, s30, v38
    v_mul_f32 v39, s30, v39
    v_cvt_pk_bf16_f32 v8, v38, v39
    v_lshlrev_b32 v38, 16, v8
    v_and_b32 v39, 0xffff0000, v8
    v_cvt_pk_bf16_f32 v8, v40, v41
    v_lshlrev_b32 v40, 16, v8
    v_and_b32 v41, 0xffff0000, v8
    v_mul_f32 v40, s30, v40
    v_mul_f32 v41, s30, v41
    v_cvt_pk_bf16_f32 v8, v40, v41
    v_lshlrev_b32 v40, 16, v8
    v_and_b32 v41, 0xffff0000, v8
    v_cvt_pk_bf16_f32 v8, v42, v43
    v_lshlrev_b32 v42, 16, v8
    v_and_b32 v43, 0xffff0000, v8
    v_mul_f32 v42, s30, v42
    v_mul_f32 v43, s30, v43
    v_cvt_pk_bf16_f32 v8, v42, v43
    v_lshlrev_b32 v42, 16, v8
    v_and_b32 v43, 0xffff0000, v8
    v_cvt_pk_bf16_f32 v8, v44, v45
    v_lshlrev_b32 v44, 16, v8
    v_and_b32 v45, 0xffff0000, v8
    v_mul_f32 v44, s30, v44
    v_mul_f32 v45, s30, v45
    v_cvt_pk_bf16_f32 v8, v44, v45
    v_lshlrev_b32 v44, 16, v8
    v_and_b32 v45, 0xffff0000, v8
    v_cvt_pk_bf16_f32 v8, v46, v47
    v_lshlrev_b32 v46, 16, v8
    v_and_b32 v47, 0xffff0000, v8
    v_mul_f32 v46, s30, v46
    v_mul_f32 v47, s30, v47
    v_cvt_pk_bf16_f32 v8, v46, v47
    v_lshlrev_b32 v46, 16, v8
    v_and_b32 v47, 0xffff0000, v8
    v_cvt_pk_bf16_f32 v8, v48, v49
    v_lshlrev_b32 v48, 16, v8
    v_and_b32 v49, 0xffff0000, v8
    v_mul_f32 v48, s30, v48
    v_mul_f32 v49, s30, v49
    v_cvt_pk_bf16_f32 v8, v48, v49
    v_lshlrev_b32 v48, 16, v8
    v_and_b32 v49, 0xffff0000, v8
    v_cvt_pk_bf16_f32 v8, v50, v51
    v_lshlrev_b32 v50, 16, v8
    v_and_b32 v51, 0xffff0000, v8
    v_mul_f32 v50, s30, v50
    v_mul_f32 v51, s30, v51
    v_cvt_pk_bf16_f32 v8, v50, v51
    v_lshlrev_b32 v50, 16, v8
    v_and_b32 v51, 0xffff0000, v8
    v_cvt_pk_bf16_f32 v8, v52, v53
    v_lshlrev_b32 v52, 16, v8
    v_and_b32 v53, 0xffff0000, v8
    v_mul_f32 v52, s30, v52
    v_mul_f32 v53, s30, v53
    v_cvt_pk_bf16_f32 v8, v52, v53
    v_lshlrev_b32 v52, 16, v8
    v_and_b32 v53, 0xffff0000, v8
    v_cvt_pk_bf16_f32 v8, v54, v55
    v_lshlrev_b32 v54, 16, v8
    v_and_b32 v55, 0xffff0000, v8
    v_mul_f32 v54, s30, v54
    v_mul_f32 v55, s30, v55
    v_cvt_pk_bf16_f32 v8, v54, v55
    v_lshlrev_b32 v54, 16, v8
    v_and_b32 v55, 0xffff0000, v8
    v_cvt_pk_bf16_f32 v8, v56, v57
    v_lshlrev_b32 v56, 16, v8
    v_and_b32 v57, 0xffff0000, v8
    v_mul_f32 v56, s30, v56
    v_mul_f32 v57, s30, v57
    v_cvt_pk_bf16_f32 v8, v56, v57
    v_lshlrev_b32 v56, 16, v8
    v_and_b32 v57, 0xffff0000, v8
    v_cvt_pk_bf16_f32 v8, v58, v59
    v_lshlrev_b32 v58, 16, v8
    v_and_b32 v59, 0xffff0000, v8
    v_mul_f32 v58, s30, v58
    v_mul_f32 v59, s30, v59
    v_cvt_pk_bf16_f32 v8, v58, v59
    v_lshlrev_b32 v58, 16, v8
    v_and_b32 v59, 0xffff0000, v8
    v_cvt_pk_bf16_f32 v8, v60, v61
    v_lshlrev_b32 v60, 16, v8
    v_and_b32 v61, 0xffff0000, v8
    v_mul_f32 v60, s30, v60
    v_mul_f32 v61, s30, v61
    v_cvt_pk_bf16_f32 v8, v60, v61
    v_lshlrev_b32 v60, 16, v8
    v_and_b32 v61, 0xffff0000, v8
    v_cvt_pk_bf16_f32 v8, v62, v63
    v_lshlrev_b32 v62, 16, v8
    v_and_b32 v63, 0xffff0000, v8
    v_mul_f32 v62, s30, v62
    v_mul_f32 v63, s30, v63
    v_cvt_pk_bf16_f32 v8, v62, v63
    v_lshlrev_b32 v62, 16, v8
    v_and_b32 v63, 0xffff0000, v8
    v_max_f32 v9, v32, v33
    v_max_f32 v9, v9, v34
    v_max_f32 v9, v9, v35
    v_max_f32 v9, v9, v36
    v_max_f32 v9, v9, v37
    v_max_f32 v9, v9, v38
    v_max_f32 v9, v9, v39
    v_max_f32 v9, v9, v40
    v_max_f32 v9, v9, v41
    v_max_f32 v9, v9, v42
    v_max_f32 v9, v9, v43
    v_max_f32 v9, v9, v44
    v_max_f32 v9, v9, v45
    v_max_f32 v9, v9, v46
    v_max_f32 v9, v9, v47
    v_max_f32 v9, v9, v48
    v_max_f32 v9, v9, v49
    v_max_f32 v9, v9, v50
    v_max_f32 v9, v9, v51
    v_max_f32 v9, v9, v52
    v_max_f32 v9, v9, v53
    v_max_f32 v9, v9, v54
    v_max_f32 v9, v9, v55
    v_max_f32 v9, v9, v56
    v_max_f32 v9, v9, v57
    v_max_f32 v9, v9, v58
    v_max_f32 v9, v9, v59
    v_max_f32 v9, v9, v60
    v_max_f32 v9, v9, v61
    v_max_f32 v9, v9, v62
    v_max_f32 v9, v9, v63
    ds_swizzle_b32 v8, v9 offset:0x401F
    s_waitcnt lgkmcnt(0)
    v_max_f32 v9, v9, v8
    v_mov_b32 v8, v9
    s_nop 1
    v_permlane32_swap_b32 v8, v9
    s_nop 1
    v_max_f32 v9, v9, v8
    s_mov_b32 s31, 0x3fb8aa3b
    v_mul_f32 v10, s31, v9
    v_mov_b32 v11, 0
    v_fma_f32 v32, v32, s31, -v10
    v_exp_f32 v32, v32
    v_fma_f32 v33, v33, s31, -v10
    v_exp_f32 v33, v33
    v_fma_f32 v34, v34, s31, -v10
    v_exp_f32 v34, v34
    v_fma_f32 v35, v35, s31, -v10
    v_exp_f32 v35, v35
    v_fma_f32 v36, v36, s31, -v10
    v_exp_f32 v36, v36
    v_fma_f32 v37, v37, s31, -v10
    v_exp_f32 v37, v37
    v_fma_f32 v38, v38, s31, -v10
    v_exp_f32 v38, v38
    v_fma_f32 v39, v39, s31, -v10
    v_exp_f32 v39, v39
    v_fma_f32 v40, v40, s31, -v10
    v_exp_f32 v40, v40
    v_fma_f32 v41, v41, s31, -v10
    v_exp_f32 v41, v41
    v_fma_f32 v42, v42, s31, -v10
    v_exp_f32 v42, v42
    v_fma_f32 v43, v43, s31, -v10
    v_exp_f32 v43, v43
    v_fma_f32 v44, v44, s31, -v10
    v_exp_f32 v44, v44
    v_fma_f32 v45, v45, s31, -v10
    v_exp_f32 v45, v45
    v_fma_f32 v46, v46, s31, -v10
    v_exp_f32 v46, v46
    v_fma_f32 v47, v47, s31, -v10
    v_exp_f32 v47, v47
    v_fma_f32 v48, v48, s31, -v10
    v_exp_f32 v48, v48
    v_fma_f32 v49, v49, s31, -v10
    v_exp_f32 v49, v49
    v_fma_f32 v50, v50, s31, -v10
    v_exp_f32 v50, v50
    v_fma_f32 v51, v51, s31, -v10
    v_exp_f32 v51, v51
    v_fma_f32 v52, v52, s31, -v10
    v_exp_f32 v52, v52
    v_fma_f32 v53, v53, s31, -v10
    v_exp_f32 v53, v53
    v_fma_f32 v54, v54, s31, -v10
    v_exp_f32 v54, v54
    v_fma_f32 v55, v55, s31, -v10
    v_exp_f32 v55, v55
    v_fma_f32 v56, v56, s31, -v10
    v_exp_f32 v56, v56
    v_fma_f32 v57, v57, s31, -v10
    v_exp_f32 v57, v57
    v_fma_f32 v58, v58, s31, -v10
    v_exp_f32 v58, v58
    v_fma_f32 v59, v59, s31, -v10
    v_exp_f32 v59, v59
    v_fma_f32 v60, v60, s31, -v10
    v_exp_f32 v60, v60
    v_fma_f32 v61, v61, s31, -v10
    v_exp_f32 v61, v61
    v_fma_f32 v62, v62, s31, -v10
    v_exp_f32 v62, v62
    v_fma_f32 v63, v63, s31, -v10
    v_exp_f32 v63, v63
    s_nop 0
    v_add_f32 v11, v11, v32
    v_add_f32 v11, v11, v33
    v_add_f32 v11, v11, v34
    v_add_f32 v11, v11, v35
    v_add_f32 v11, v11, v36
    v_add_f32 v11, v11, v37
    v_add_f32 v11, v11, v38
    v_add_f32 v11, v11, v39
    v_add_f32 v11, v11, v40
    v_add_f32 v11, v11, v41
    v_add_f32 v11, v11, v42
    v_add_f32 v11, v11, v43
    v_add_f32 v11, v11, v44
    v_add_f32 v11, v11, v45
    v_add_f32 v11, v11, v46
    v_add_f32 v11, v11, v47
    v_add_f32 v11, v11, v48
    v_add_f32 v11, v11, v49
    v_add_f32 v11, v11, v50
    v_add_f32 v11, v11, v51
    v_add_f32 v11, v11, v52
    v_add_f32 v11, v11, v53
    v_add_f32 v11, v11, v54
    v_add_f32 v11, v11, v55
    v_add_f32 v11, v11, v56
    v_add_f32 v11, v11, v57
    v_add_f32 v11, v11, v58
    v_add_f32 v11, v11, v59
    v_add_f32 v11, v11, v60
    v_add_f32 v11, v11, v61
    v_add_f32 v11, v11, v62
    v_add_f32 v11, v11, v63
    v_cvt_pk_bf16_f32 v12, v32, v33
    v_cvt_pk_bf16_f32 v13, v34, v35
    v_cvt_pk_bf16_f32 v14, v36, v37
    v_cvt_pk_bf16_f32 v15, v38, v39
    v_mov_b32 v32, v12
    v_mov_b32 v33, v13
    v_mov_b32 v34, v14
    v_mov_b32 v35, v15
    v_cvt_pk_bf16_f32 v12, v40, v41
    v_cvt_pk_bf16_f32 v13, v42, v43
    v_cvt_pk_bf16_f32 v14, v44, v45
    v_cvt_pk_bf16_f32 v15, v46, v47
    v_mov_b32 v36, v12
    v_mov_b32 v37, v13
    v_mov_b32 v38, v14
    v_mov_b32 v39, v15
    v_cvt_pk_bf16_f32 v12, v48, v49
    v_cvt_pk_bf16_f32 v13, v50, v51
    v_cvt_pk_bf16_f32 v14, v52, v53
    v_cvt_pk_bf16_f32 v15, v54, v55
    v_mov_b32 v40, v12
    v_mov_b32 v41, v13
    v_mov_b32 v42, v14
    v_mov_b32 v43, v15
    v_cvt_pk_bf16_f32 v12, v56, v57
    v_cvt_pk_bf16_f32 v13, v58, v59
    v_cvt_pk_bf16_f32 v14, v60, v61
    v_cvt_pk_bf16_f32 v15, v62, v63
    v_mov_b32 v44, v12
    v_mov_b32 v45, v13
    v_mov_b32 v46, v14
    v_mov_b32 v47, v15
    s_mov_b32 s32, 0x05040100
    s_mov_b32 s33, 0x07060302
    s_waitcnt vmcnt(24)
    v_perm_b32 v48, v196, v192, s32
    v_perm_b32 v49, v204, v200, s32
    v_perm_b32 v50, v212, v208, s32
    v_perm_b32 v51, v220, v216, s32
    v_perm_b32 v52, v196, v192, s33
    v_perm_b32 v53, v204, v200, s33
    v_perm_b32 v54, v212, v208, s33
    v_perm_b32 v55, v220, v216, s33
    v_perm_b32 v56, v197, v193, s32
    v_perm_b32 v57, v205, v201, s32
    v_perm_b32 v58, v213, v209, s32
    v_perm_b32 v59, v221, v217, s32
    v_perm_b32 v60, v197, v193, s33
    v_perm_b32 v61, v205, v201, s33
    v_perm_b32 v62, v213, v209, s33
    v_perm_b32 v63, v221, v217, s33
    v_perm_b32 v16, v198, v194, s32
    v_perm_b32 v17, v206, v202, s32
    v_perm_b32 v18, v214, v210, s32
    v_perm_b32 v19, v222, v218, s32
    v_perm_b32 v20, v198, v194, s33
    v_perm_b32 v21, v206, v202, s33
    v_perm_b32 v22, v214, v210, s33
    v_perm_b32 v23, v222, v218, s33
    v_perm_b32 v24, v199, v195, s32
    v_perm_b32 v25, v207, v203, s32
    v_perm_b32 v26, v215, v211, s32
    v_perm_b32 v27, v223, v219, s32
    v_perm_b32 v28, v199, v195, s33
    v_perm_b32 v29, v207, v203, s33
    v_perm_b32 v30, v215, v211, s33
    v_perm_b32 v31, v223, v219, s33
    s_nop 1
    v_mfma_f32_16x16x32_bf16 v[224:227], v[32:35], v[48:51], v[224:227]
    v_mfma_f32_16x16x32_bf16 v[228:231], v[32:35], v[52:55], v[228:231]
    v_mfma_f32_16x16x32_bf16 v[232:235], v[32:35], v[56:59], v[232:235]
    v_mfma_f32_16x16x32_bf16 v[236:239], v[32:35], v[60:63], v[236:239]
    v_mfma_f32_16x16x32_bf16 v[240:243], v[32:35], v[16:19], v[240:243]
    v_mfma_f32_16x16x32_bf16 v[244:247], v[32:35], v[20:23], v[244:247]
    v_mfma_f32_16x16x32_bf16 v[248:251], v[32:35], v[24:27], v[248:251]
    v_mfma_f32_16x16x32_bf16 v[252:255], v[32:35], v[28:31], v[252:255]
    s_waitcnt vmcnt(16)
    v_perm_b32 v48, v68, v64, s32
    v_perm_b32 v49, v76, v72, s32
    v_perm_b32 v50, v84, v80, s32
    v_perm_b32 v51, v92, v88, s32
    v_perm_b32 v52, v68, v64, s33
    v_perm_b32 v53, v76, v72, s33
    v_perm_b32 v54, v84, v80, s33
    v_perm_b32 v55, v92, v88, s33
    v_perm_b32 v56, v69, v65, s32
    v_perm_b32 v57, v77, v73, s32
    v_perm_b32 v58, v85, v81, s32
    v_perm_b32 v59, v93, v89, s32
    v_perm_b32 v60, v69, v65, s33
    v_perm_b32 v61, v77, v73, s33
    v_perm_b32 v62, v85, v81, s33
    v_perm_b32 v63, v93, v89, s33
    v_perm_b32 v16, v70, v66, s32
    v_perm_b32 v17, v78, v74, s32
    v_perm_b32 v18, v86, v82, s32
    v_perm_b32 v19, v94, v90, s32
    v_perm_b32 v20, v70, v66, s33
    v_perm_b32 v21, v78, v74, s33
    v_perm_b32 v22, v86, v82, s33
    v_perm_b32 v23, v94, v90, s33
    v_perm_b32 v24, v71, v67, s32
    v_perm_b32 v25, v79, v75, s32
    v_perm_b32 v26, v87, v83, s32
    v_perm_b32 v27, v95, v91, s32
    v_perm_b32 v28, v71, v67, s33
    v_perm_b32 v29, v79, v75, s33
    v_perm_b32 v30, v87, v83, s33
    v_perm_b32 v31, v95, v91, s33
    s_nop 1
    v_mfma_f32_16x16x32_bf16 v[224:227], v[36:39], v[48:51], v[224:227]
    v_mfma_f32_16x16x32_bf16 v[228:231], v[36:39], v[52:55], v[228:231]
    v_mfma_f32_16x16x32_bf16 v[232:235], v[36:39], v[56:59], v[232:235]
    v_mfma_f32_16x16x32_bf16 v[236:239], v[36:39], v[60:63], v[236:239]
    v_mfma_f32_16x16x32_bf16 v[240:243], v[36:39], v[16:19], v[240:243]
    v_mfma_f32_16x16x32_bf16 v[244:247], v[36:39], v[20:23], v[244:247]
    v_mfma_f32_16x16x32_bf16 v[248:251], v[36:39], v[24:27], v[248:251]
    v_mfma_f32_16x16x32_bf16 v[252:255], v[36:39], v[28:31], v[252:255]
    s_waitcnt vmcnt(8)
    v_perm_b32 v48, v100, v96, s32
    v_perm_b32 v49, v108, v104, s32
    v_perm_b32 v50, v116, v112, s32
    v_perm_b32 v51, v124, v120, s32
    v_perm_b32 v52, v100, v96, s33
    v_perm_b32 v53, v108, v104, s33
    v_perm_b32 v54, v116, v112, s33
    v_perm_b32 v55, v124, v120, s33
    v_perm_b32 v56, v101, v97, s32
    v_perm_b32 v57, v109, v105, s32
    v_perm_b32 v58, v117, v113, s32
    v_perm_b32 v59, v125, v121, s32
    v_perm_b32 v60, v101, v97, s33
    v_perm_b32 v61, v109, v105, s33
    v_perm_b32 v62, v117, v113, s33
    v_perm_b32 v63, v125, v121, s33
    v_perm_b32 v16, v102, v98, s32
    v_perm_b32 v17, v110, v106, s32
    v_perm_b32 v18, v118, v114, s32
    v_perm_b32 v19, v126, v122, s32
    v_perm_b32 v20, v102, v98, s33
    v_perm_b32 v21, v110, v106, s33
    v_perm_b32 v22, v118, v114, s33
    v_perm_b32 v23, v126, v122, s33
    v_perm_b32 v24, v103, v99, s32
    v_perm_b32 v25, v111, v107, s32
    v_perm_b32 v26, v119, v115, s32
    v_perm_b32 v27, v127, v123, s32
    v_perm_b32 v28, v103, v99, s33
    v_perm_b32 v29, v111, v107, s33
    v_perm_b32 v30, v119, v115, s33
    v_perm_b32 v31, v127, v123, s33
    s_nop 1
    v_mfma_f32_16x16x32_bf16 v[224:227], v[40:43], v[48:51], v[224:227]
    v_mfma_f32_16x16x32_bf16 v[228:231], v[40:43], v[52:55], v[228:231]
    v_mfma_f32_16x16x32_bf16 v[232:235], v[40:43], v[56:59], v[232:235]
    v_mfma_f32_16x16x32_bf16 v[236:239], v[40:43], v[60:63], v[236:239]
    v_mfma_f32_16x16x32_bf16 v[240:243], v[40:43], v[16:19], v[240:243]
    v_mfma_f32_16x16x32_bf16 v[244:247], v[40:43], v[20:23], v[244:247]
    v_mfma_f32_16x16x32_bf16 v[248:251], v[40:43], v[24:27], v[248:251]
    v_mfma_f32_16x16x32_bf16 v[252:255], v[40:43], v[28:31], v[252:255]
    s_waitcnt vmcnt(0)
    v_perm_b32 v48, v132, v128, s32
    v_perm_b32 v49, v140, v136, s32
    v_perm_b32 v50, v148, v144, s32
    v_perm_b32 v51, v156, v152, s32
    v_perm_b32 v52, v132, v128, s33
    v_perm_b32 v53, v140, v136, s33
    v_perm_b32 v54, v148, v144, s33
    v_perm_b32 v55, v156, v152, s33
    v_perm_b32 v56, v133, v129, s32
    v_perm_b32 v57, v141, v137, s32
    v_perm_b32 v58, v149, v145, s32
    v_perm_b32 v59, v157, v153, s32
    v_perm_b32 v60, v133, v129, s33
    v_perm_b32 v61, v141, v137, s33
    v_perm_b32 v62, v149, v145, s33
    v_perm_b32 v63, v157, v153, s33
    v_perm_b32 v16, v134, v130, s32
    v_perm_b32 v17, v142, v138, s32
    v_perm_b32 v18, v150, v146, s32
    v_perm_b32 v19, v158, v154, s32
    v_perm_b32 v20, v134, v130, s33
    v_perm_b32 v21, v142, v138, s33
    v_perm_b32 v22, v150, v146, s33
    v_perm_b32 v23, v158, v154, s33
    v_perm_b32 v24, v135, v131, s32
    v_perm_b32 v25, v143, v139, s32
    v_perm_b32 v26, v151, v147, s32
    v_perm_b32 v27, v159, v155, s32
    v_perm_b32 v28, v135, v131, s33
    v_perm_b32 v29, v143, v139, s33
    v_perm_b32 v30, v151, v147, s33
    v_perm_b32 v31, v159, v155, s33
    s_nop 1
    v_mfma_f32_16x16x32_bf16 v[224:227], v[44:47], v[48:51], v[224:227]
    v_mfma_f32_16x16x32_bf16 v[228:231], v[44:47], v[52:55], v[228:231]
    v_mfma_f32_16x16x32_bf16 v[232:235], v[44:47], v[56:59], v[232:235]
    v_mfma_f32_16x16x32_bf16 v[236:239], v[44:47], v[60:63], v[236:239]
    v_mfma_f32_16x16x32_bf16 v[240:243], v[44:47], v[16:19], v[240:243]
    v_mfma_f32_16x16x32_bf16 v[244:247], v[44:47], v[20:23], v[244:247]
    v_mfma_f32_16x16x32_bf16 v[248:251], v[44:47], v[24:27], v[248:251]
    v_mfma_f32_16x16x32_bf16 v[252:255], v[44:47], v[28:31], v[252:255]
    ds_swizzle_b32 v8, v11 offset:0x401F
    s_waitcnt lgkmcnt(0)
    v_add_f32 v11, v11, v8
    v_mov_b32 v8, v11
    s_nop 1
    v_permlane32_swap_b32 v8, v11
    s_nop 1
    v_add_f32 v11, v11, v8
    v_lshlrev_b32 v12, 5, v1
    v_lshl_add_u32 v12, v3, 2, v12
    v_cmp_gt_u32 vcc, 8, v2
    s_and_saveexec_b64 s[34:35], vcc
    ds_write_b32 v12, v9
    ds_write_b32 v12, v11 offset:256
    s_mov_b64 exec, s[34:35]
    s_nop 7
    s_nop 7
    v_cmp_gt_u32 vcc, 32, v2
    s_and_saveexec_b64 s[34:35], vcc
    v_lshlrev_b32 v13, 12, v1
    v_lshl_add_u32 v13, v4, 11, v13
    v_lshl_add_u32 v13, v3, 5, v13
    ds_write_b32 v13, v224 offset:512
    ds_write_b32 v13, v225 offset:1024
    ds_write_b32 v13, v226 offset:1536
    ds_write_b32 v13, v227 offset:2048
    ds_write_b32 v13, v228 offset:516
    ds_write_b32 v13, v229 offset:1028
    ds_write_b32 v13, v230 offset:1540
    ds_write_b32 v13, v231 offset:2052
    ds_write_b32 v13, v232 offset:520
    ds_write_b32 v13, v233 offset:1032
    ds_write_b32 v13, v234 offset:1544
    ds_write_b32 v13, v235 offset:2056
    ds_write_b32 v13, v236 offset:524
    ds_write_b32 v13, v237 offset:1036
    ds_write_b32 v13, v238 offset:1548
    ds_write_b32 v13, v239 offset:2060
    ds_write_b32 v13, v240 offset:528
    ds_write_b32 v13, v241 offset:1040
    ds_write_b32 v13, v242 offset:1552
    ds_write_b32 v13, v243 offset:2064
    ds_write_b32 v13, v244 offset:532
    ds_write_b32 v13, v245 offset:1044
    ds_write_b32 v13, v246 offset:1556
    ds_write_b32 v13, v247 offset:2068
    ds_write_b32 v13, v248 offset:536
    ds_write_b32 v13, v249 offset:1048
    ds_write_b32 v13, v250 offset:1560
    ds_write_b32 v13, v251 offset:2072
    ds_write_b32 v13, v252 offset:540
    ds_write_b32 v13, v253 offset:1052
    ds_write_b32 v13, v254 offset:1564
    ds_write_b32 v13, v255 offset:2076
    s_mov_b64 exec, s[34:35]
    s_waitcnt lgkmcnt(0)
    s_barrier
    v_lshlrev_b32 v12, 2, v1
    ds_read_b32 v16, v12 offset:0
    ds_read_b32 v24, v12 offset:256
    ds_read_b32 v17, v12 offset:32
    ds_read_b32 v25, v12 offset:288
    ds_read_b32 v18, v12 offset:64
    ds_read_b32 v26, v12 offset:320
    ds_read_b32 v19, v12 offset:96
    ds_read_b32 v27, v12 offset:352
    ds_read_b32 v20, v12 offset:128
    ds_read_b32 v28, v12 offset:384
    ds_read_b32 v21, v12 offset:160
    ds_read_b32 v29, v12 offset:416
    ds_read_b32 v22, v12 offset:192
    ds_read_b32 v30, v12 offset:448
    ds_read_b32 v23, v12 offset:224
    ds_read_b32 v31, v12 offset:480
    v_lshlrev_b32 v13, 9, v1
    v_lshl_add_u32 v13, v2, 3, v13
    ds_read_b64 v[32:33], v13 offset:512
    ds_read_b64 v[34:35], v13 offset:4608
    ds_read_b64 v[36:37], v13 offset:8704
    ds_read_b64 v[38:39], v13 offset:12800
    ds_read_b64 v[40:41], v13 offset:16896
    ds_read_b64 v[42:43], v13 offset:20992
    ds_read_b64 v[44:45], v13 offset:25088
    ds_read_b64 v[46:47], v13 offset:29184
    s_waitcnt lgkmcnt(0)
    v_max_f32 v9, v16, v17
    v_max_f32 v9, v9, v18
    v_max_f32 v9, v9, v19
    v_max_f32 v9, v9, v20
    v_max_f32 v9, v9, v21
    v_max_f32 v9, v9, v22
    v_max_f32 v9, v9, v23
    v_mov_b32 v10, 0
    v_mov_b32 v14, 0
    v_mov_b32 v15, 0
    v_sub_f32 v8, v16, v9
    v_mul_f32 v8, s31, v8
    v_exp_f32 v8, v8
    s_nop 0
    v_fmac_f32 v10, v8, v24
    v_fmac_f32 v14, v8, v32
    v_fmac_f32 v15, v8, v33
    v_sub_f32 v8, v17, v9
    v_mul_f32 v8, s31, v8
    v_exp_f32 v8, v8
    s_nop 0
    v_fmac_f32 v10, v8, v25
    v_fmac_f32 v14, v8, v34
    v_fmac_f32 v15, v8, v35
    v_sub_f32 v8, v18, v9
    v_mul_f32 v8, s31, v8
    v_exp_f32 v8, v8
    s_nop 0
    v_fmac_f32 v10, v8, v26
    v_fmac_f32 v14, v8, v36
    v_fmac_f32 v15, v8, v37
    v_sub_f32 v8, v19, v9
    v_mul_f32 v8, s31, v8
    v_exp_f32 v8, v8
    s_nop 0
    v_fmac_f32 v10, v8, v27
    v_fmac_f32 v14, v8, v38
    v_fmac_f32 v15, v8, v39
    v_sub_f32 v8, v20, v9
    v_mul_f32 v8, s31, v8
    v_exp_f32 v8, v8
    s_nop 0
    v_fmac_f32 v10, v8, v28
    v_fmac_f32 v14, v8, v40
    v_fmac_f32 v15, v8, v41
    v_sub_f32 v8, v21, v9
    v_mul_f32 v8, s31, v8
    v_exp_f32 v8, v8
    s_nop 0
    v_fmac_f32 v10, v8, v29
    v_fmac_f32 v14, v8, v42
    v_fmac_f32 v15, v8, v43
    v_sub_f32 v8, v22, v9
    v_mul_f32 v8, s31, v8
    v_exp_f32 v8, v8
    s_nop 0
    v_fmac_f32 v10, v8, v30
    v_fmac_f32 v14, v8, v44
    v_fmac_f32 v15, v8, v45
    v_sub_f32 v8, v23, v9
    v_mul_f32 v8, s31, v8
    v_exp_f32 v8, v8
    s_nop 0
    v_fmac_f32 v10, v8, v31
    v_fmac_f32 v14, v8, v46
    v_fmac_f32 v15, v8, v47
    s_lshl_b32 s36, s2, 12
    s_add_u32 s36, s36, 1048576
    buffer_store_dwordx2 v[14:15], v13, s[20:23], s36 offen
    v_cmp_eq_u32 vcc, 0, v2
    s_and_saveexec_b64 s[34:35], vcc
    s_lshl_b32 s36, s2, 5
    s_add_u32 s36, s36, 262144
    s_add_u32 s37, s36, 8192
    buffer_store_dword v9, v12, s[20:23], s36 offen
    buffer_store_dword v10, v12, s[20:23], s37 offen
k3_attn_kernel_end:
    s_endpgm
.p2align 8
.globl k4_wo_kernel
.type k4_wo_kernel,@function
k4_wo_kernel:
    s_cmp_ge_u32 s2, 256
    s_cbranch_scc1 k4_wo_kernel_end
    s_load_dwordx2 s[6:7], s[0:1], 32
    s_load_dwordx2 s[8:9], s[0:1], 104
    s_waitcnt lgkmcnt(0)
    s_mov_b32 s16, s6
    s_mov_b32 s17, s7
    s_mov_b32 s18, 8388608
    s_mov_b32 s19, 0x00020000
    s_mov_b32 s20, s8
    s_mov_b32 s21, s9
    s_mov_b32 s22, 268435456
    s_mov_b32 s23, 0x00020000
    s_lshr_b32 s26, s2, 3
    s_and_b32 s27, s2, 7
    s_lshl_b32 s24, s27, 8
    s_lshl_b32 s25, s26, 7
    v_and_b32 v2, 15, v0
    v_lshrrev_b32 v3, 4, v0
    v_add_u32 v4, s25, v3
    s_mov_b32 s90, 2048
    v_mul_lo_u32 v5, v4, s90
    v_lshlrev_b32 v6, 4, v2
    v_add3_u32 v5, v5, v6, s24
    s_mov_b32 s91, 0
    buffer_load_dwordx4 v[64:67], v5, s[16:19], s91 offen
    s_mov_b32 s91, 65536
    buffer_load_dwordx4 v[68:71], v5, s[16:19], s91 offen
    s_mov_b32 s91, 131072
    buffer_load_dwordx4 v[72:75], v5, s[16:19], s91 offen
    s_mov_b32 s91, 196608
    buffer_load_dwordx4 v[76:79], v5, s[16:19], s91 offen
    s_lshr_b32 s28, s26, 3
    s_and_b32 s29, s26, 7
    s_lshl_b32 s30, s28, 11
    s_lshl_b32 s31, s29, 2
    s_add_u32 s30, s30, s31
    v_and_b32 v1, 63, v0
    v_lshlrev_b32 v8, 5, v1
    s_add_u32 s30, s30, 262144
    s_add_u32 s33, s30, 8192
    buffer_load_dword v9, v8, s[20:23], s30 offen
    buffer_load_dword v10, v8, s[20:23], s33 offen
    v_and_b32 v11, 127, v0
    v_lshrrev_b32 v12, 7, v0
    v_lshlrev_b32 v13, 16, v12
    v_lshl_add_u32 v13, v11, 2, v13
    s_lshl_b32 s31, s28, 18
    s_lshl_b32 s32, s29, 9
    s_add_u32 s31, s31, s32
    s_add_u32 s31, s31, 1048576
    buffer_load_dword v96, v13, s[20:23], s31 offen offset:0
    s_add_u32 s31, s31, 4096
    buffer_load_dword v97, v13, s[20:23], s31 offen offset:0
    s_add_u32 s31, s31, 4096
    buffer_load_dword v98, v13, s[20:23], s31 offen offset:0
    s_add_u32 s31, s31, 4096
    buffer_load_dword v99, v13, s[20:23], s31 offen offset:0
    s_add_u32 s31, s31, 4096
    buffer_load_dword v100, v13, s[20:23], s31 offen offset:0
    s_add_u32 s31, s31, 4096
    buffer_load_dword v101, v13, s[20:23], s31 offen offset:0
    s_add_u32 s31, s31, 4096
    buffer_load_dword v102, v13, s[20:23], s31 offen offset:0
    s_add_u32 s31, s31, 4096
    buffer_load_dword v103, v13, s[20:23], s31 offen offset:0
    s_add_u32 s31, s31, 4096
    buffer_load_dword v104, v13, s[20:23], s31 offen offset:0
    s_add_u32 s31, s31, 4096
    buffer_load_dword v105, v13, s[20:23], s31 offen offset:0
    s_add_u32 s31, s31, 4096
    buffer_load_dword v106, v13, s[20:23], s31 offen offset:0
    s_add_u32 s31, s31, 4096
    buffer_load_dword v107, v13, s[20:23], s31 offen offset:0
    s_add_u32 s31, s31, 4096
    buffer_load_dword v108, v13, s[20:23], s31 offen offset:0
    s_add_u32 s31, s31, 4096
    buffer_load_dword v109, v13, s[20:23], s31 offen offset:0
    s_add_u32 s31, s31, 4096
    buffer_load_dword v110, v13, s[20:23], s31 offen offset:0
    s_add_u32 s31, s31, 4096
    buffer_load_dword v111, v13, s[20:23], s31 offen offset:0
    s_add_u32 s31, s31, 4096
    s_waitcnt vmcnt(16)
    v_mov_b32 v14, v9
    ds_swizzle_b32 v15, v14 offset:0x41f
    s_waitcnt lgkmcnt(0)
    v_max_f32 v14, v14, v15
    ds_swizzle_b32 v15, v14 offset:0x81f
    s_waitcnt lgkmcnt(0)
    v_max_f32 v14, v14, v15
    ds_swizzle_b32 v15, v14 offset:0x101f
    s_waitcnt lgkmcnt(0)
    v_max_f32 v14, v14, v15
    ds_swizzle_b32 v15, v14 offset:0x201f
    s_waitcnt lgkmcnt(0)
    v_max_f32 v14, v14, v15
    ds_swizzle_b32 v15, v14 offset:0x401f
    s_waitcnt lgkmcnt(0)
    v_max_f32 v14, v14, v15
    v_mov_b32 v15, v14
    s_nop 1
    v_permlane32_swap_b32 v15, v14
    s_nop 1
    v_max_f32 v14, v14, v15
    v_sub_f32 v9, v9, v14
    v_mul_f32 v9, 0x3fb8aa3b, v9
    v_exp_f32 v9, v9
    s_nop 0
    v_mul_f32 v10, v9, v10
    ds_swizzle_b32 v15, v10 offset:0x41f
    s_waitcnt lgkmcnt(0)
    v_add_f32 v10, v10, v15
    ds_swizzle_b32 v15, v10 offset:0x81f
    s_waitcnt lgkmcnt(0)
    v_add_f32 v10, v10, v15
    ds_swizzle_b32 v15, v10 offset:0x101f
    s_waitcnt lgkmcnt(0)
    v_add_f32 v10, v10, v15
    ds_swizzle_b32 v15, v10 offset:0x201f
    s_waitcnt lgkmcnt(0)
    v_add_f32 v10, v10, v15
    ds_swizzle_b32 v15, v10 offset:0x401f
    s_waitcnt lgkmcnt(0)
    v_add_f32 v10, v10, v15
    v_mov_b32 v15, v10
    s_nop 1
    v_permlane32_swap_b32 v15, v10
    s_nop 1
    v_add_f32 v10, v10, v15
    v_rcp_f32 v10, v10
    s_nop 0
    v_mul_f32 v9, v9, v10
    v_lshlrev_b32 v8, 2, v0
    ds_write_b32 v8, v9 offset:2048
    s_waitcnt lgkmcnt(0)
    s_barrier
    v_lshlrev_b32 v8, 6, v12
    ds_read_b128 v[16:19], v8 offset:2048
    ds_read_b128 v[20:23], v8 offset:2064
    ds_read_b128 v[24:27], v8 offset:2080
    ds_read_b128 v[28:31], v8 offset:2096
    v_mov_b32 v14, 0
    s_waitcnt vmcnt(0) lgkmcnt(0)
    v_fmac_f32 v14, v16, v96
    v_fmac_f32 v14, v17, v97
    v_fmac_f32 v14, v18, v98
    v_fmac_f32 v14, v19, v99
    v_fmac_f32 v14, v20, v100
    v_fmac_f32 v14, v21, v101
    v_fmac_f32 v14, v22, v102
    v_fmac_f32 v14, v23, v103
    v_fmac_f32 v14, v24, v104
    v_fmac_f32 v14, v25, v105
    v_fmac_f32 v14, v26, v106
    v_fmac_f32 v14, v27, v107
    v_fmac_f32 v14, v28, v108
    v_fmac_f32 v14, v29, v109
    v_fmac_f32 v14, v30, v110
    v_fmac_f32 v14, v31, v111
    s_barrier
    v_lshlrev_b32 v8, 2, v0
    ds_write_b32 v8, v14 offset:2048
    s_waitcnt lgkmcnt(0)
    s_barrier
    v_and_b32 v8, 127, v0
    v_lshlrev_b32 v8, 2, v8
    ds_read_b32 v16, v8 offset:2048
    ds_read_b32 v17, v8 offset:2560
    ds_read_b32 v18, v8 offset:3072
    ds_read_b32 v19, v8 offset:3584
    s_waitcnt lgkmcnt(0)
    v_add_f32 v16, v16, v17
    v_add_f32 v18, v18, v19
    v_add_f32 v16, v16, v18
    v_cvt_pk_bf16_f32 v17, v16, v16
    v_lshlrev_b32 v16, 16, v17
    ds_write_b32 v8, v16
    s_waitcnt lgkmcnt(0)
    s_barrier
    v_and_b32 v4, 127, v4
    v_lshlrev_b32 v7, 2, v4
    ds_read_b32 v16, v7 offset:0
    ds_read_b32 v17, v7 offset:128
    ds_read_b32 v18, v7 offset:256
    ds_read_b32 v19, v7 offset:384
    v_mov_b32 v32, 0
    v_mov_b32 v33, 0
    v_mov_b32 v34, 0
    v_mov_b32 v35, 0
    v_mov_b32 v36, 0
    v_mov_b32 v37, 0
    v_mov_b32 v38, 0
    v_mov_b32 v39, 0
    s_waitcnt vmcnt(0) lgkmcnt(0)
    v_lshlrev_b32 v8, 16, v64
    v_and_b32 v9, 0xffff0000, v64
    v_fmac_f32 v32, v16, v8
    v_fmac_f32 v33, v16, v9
    v_lshlrev_b32 v8, 16, v65
    v_and_b32 v9, 0xffff0000, v65
    v_fmac_f32 v34, v16, v8
    v_fmac_f32 v35, v16, v9
    v_lshlrev_b32 v8, 16, v66
    v_and_b32 v9, 0xffff0000, v66
    v_fmac_f32 v36, v16, v8
    v_fmac_f32 v37, v16, v9
    v_lshlrev_b32 v8, 16, v67
    v_and_b32 v9, 0xffff0000, v67
    v_fmac_f32 v38, v16, v8
    v_fmac_f32 v39, v16, v9
    v_lshlrev_b32 v8, 16, v68
    v_and_b32 v9, 0xffff0000, v68
    v_fmac_f32 v32, v17, v8
    v_fmac_f32 v33, v17, v9
    v_lshlrev_b32 v8, 16, v69
    v_and_b32 v9, 0xffff0000, v69
    v_fmac_f32 v34, v17, v8
    v_fmac_f32 v35, v17, v9
    v_lshlrev_b32 v8, 16, v70
    v_and_b32 v9, 0xffff0000, v70
    v_fmac_f32 v36, v17, v8
    v_fmac_f32 v37, v17, v9
    v_lshlrev_b32 v8, 16, v71
    v_and_b32 v9, 0xffff0000, v71
    v_fmac_f32 v38, v17, v8
    v_fmac_f32 v39, v17, v9
    v_lshlrev_b32 v8, 16, v72
    v_and_b32 v9, 0xffff0000, v72
    v_fmac_f32 v32, v18, v8
    v_fmac_f32 v33, v18, v9
    v_lshlrev_b32 v8, 16, v73
    v_and_b32 v9, 0xffff0000, v73
    v_fmac_f32 v34, v18, v8
    v_fmac_f32 v35, v18, v9
    v_lshlrev_b32 v8, 16, v74
    v_and_b32 v9, 0xffff0000, v74
    v_fmac_f32 v36, v18, v8
    v_fmac_f32 v37, v18, v9
    v_lshlrev_b32 v8, 16, v75
    v_and_b32 v9, 0xffff0000, v75
    v_fmac_f32 v38, v18, v8
    v_fmac_f32 v39, v18, v9
    v_lshlrev_b32 v8, 16, v76
    v_and_b32 v9, 0xffff0000, v76
    v_fmac_f32 v32, v19, v8
    v_fmac_f32 v33, v19, v9
    v_lshlrev_b32 v8, 16, v77
    v_and_b32 v9, 0xffff0000, v77
    v_fmac_f32 v34, v19, v8
    v_fmac_f32 v35, v19, v9
    v_lshlrev_b32 v8, 16, v78
    v_and_b32 v9, 0xffff0000, v78
    v_fmac_f32 v36, v19, v8
    v_fmac_f32 v37, v19, v9
    v_lshlrev_b32 v8, 16, v79
    v_and_b32 v9, 0xffff0000, v79
    v_fmac_f32 v38, v19, v8
    v_fmac_f32 v39, v19, v9
    v_lshlrev_b32 v7, 5, v0
    ds_write_b128 v7, v[32:35] offset:4096
    ds_write_b128 v7, v[36:39] offset:4112
    s_waitcnt lgkmcnt(0)
    s_barrier
    v_and_b32 v10, 127, v0
    v_lshrrev_b32 v11, 7, v0
    v_mul_u32_u24 v12, 4096, v11
    v_lshl_add_u32 v12, v10, 2, v12
    ds_read_b32 v16, v12 offset:4096
    ds_read_b32 v17, v12 offset:4608
    ds_read_b32 v18, v12 offset:5120
    ds_read_b32 v19, v12 offset:5632
    ds_read_b32 v20, v12 offset:6144
    ds_read_b32 v21, v12 offset:6656
    ds_read_b32 v22, v12 offset:7168
    ds_read_b32 v23, v12 offset:7680
    s_waitcnt lgkmcnt(0)
    v_add_f32 v16, v16, v17
    v_add_f32 v16, v16, v18
    v_add_f32 v16, v16, v19
    v_add_f32 v16, v16, v20
    v_add_f32 v16, v16, v21
    v_add_f32 v16, v16, v22
    v_add_f32 v16, v16, v23
    v_mov_b32 v48, v16
    s_barrier
    v_lshlrev_b32 v12, 2, v0
    ds_write_b32 v12, v48 offset:4096
    s_waitcnt lgkmcnt(0)
    s_barrier
    v_lshlrev_b32 v12, 2, v10
    ds_read_b32 v16, v12 offset:4096
    ds_read_b32 v17, v12 offset:4608
    ds_read_b32 v18, v12 offset:5120
    ds_read_b32 v19, v12 offset:5632
    s_waitcnt lgkmcnt(0)
    v_add_f32 v16, v16, v17
    v_add_f32 v16, v16, v18
    v_add_f32 v16, v16, v19
    v_mov_b32 v50, v16
    v_cmp_gt_u32 vcc, 128, v0
    s_and_saveexec_b64 s[34:35], vcc
    v_lshlrev_b32 v11, 2, v0
    s_lshl_b32 s27, s27, 9
    s_add_u32 s27, s27, 49152
    v_add_u32 v11, s27, v11
    global_atomic_add_f32 v11, v50, s[8:9]
k4_wo_kernel_end:
    s_endpgm
.p2align 8
.globl k5_gu_kernel
.type k5_gu_kernel,@function
k5_gu_kernel:
    s_cmp_ge_u32 s2, 224
    s_cbranch_scc1 k5_gu_kernel_end
    s_load_dwordx2 s[4:5], s[0:1], 0
    s_load_dwordx2 s[6:7], s[0:1], 48
    s_load_dwordx2 s[10:11], s[0:1], 56
    s_load_dwordx2 s[8:9], s[0:1], 104
    s_waitcnt lgkmcnt(0)
    s_mov_b32 s12, s4
    s_mov_b32 s13, s5
    s_mov_b32 s14, 2048
    s_mov_b32 s15, 0x00020000
    s_mov_b32 s16, s6
    s_mov_b32 s17, s7
    s_mov_b32 s18, 7340032
    s_mov_b32 s19, 0x00020000
    s_mov_b32 s24, s10
    s_mov_b32 s25, s11
    s_mov_b32 s26, 7340032
    s_mov_b32 s27, 0x00020000
    s_mov_b32 s20, s8
    s_mov_b32 s21, s9
    s_mov_b32 s22, 268435456
    s_mov_b32 s23, 0x00020000
    v_lshlrev_b32 v1, 2, v0
    buffer_load_dword v10, v1, s[12:15], 0 offen
    s_mov_b32 s28, 0x4924924a
    s_mul_hi_u32 s29, s2, 0x04924925
    s_mul_i32 s30, s29, 56
    s_sub_u32 s30, s2, s30
    s_lshl_b32 s32, s30, 7
    s_lshl_b32 s33, s29, 8
    v_and_b32 v2, 7, v0
    v_lshrrev_b32 v3, 3, v0
    v_add_u32 v4, s33, v3
    s_mov_b32 s90, 7168
    v_mul_lo_u32 v5, v4, s90
    v_lshlrev_b32 v6, 4, v2
    v_add3_u32 v5, v5, v6, s32
    s_mov_b32 s91, 0
    buffer_load_dwordx4 v[64:67], v5, s[16:19], s91 offen
    buffer_load_dwordx4 v[80:83], v5, s[24:27], s91 offen
    s_mov_b32 s91, 458752
    buffer_load_dwordx4 v[68:71], v5, s[16:19], s91 offen
    buffer_load_dwordx4 v[84:87], v5, s[24:27], s91 offen
    s_mov_b32 s91, 917504
    buffer_load_dwordx4 v[72:75], v5, s[16:19], s91 offen
    buffer_load_dwordx4 v[88:91], v5, s[24:27], s91 offen
    s_mov_b32 s91, 1376256
    buffer_load_dwordx4 v[76:79], v5, s[16:19], s91 offen
    buffer_load_dwordx4 v[92:95], v5, s[24:27], s91 offen
    v_lshlrev_b32 v20, 3, v0
    s_mov_b32 s93, 49152
    buffer_load_dwordx2 v[44:45], v20, s[20:23], s93 offen
    s_mov_b32 s92, 8192
    buffer_load_dwordx2 v[46:47], v20, s[20:23], s92 offen
    s_waitcnt vmcnt(0)
    v_lshlrev_b32 v12, 16, v10
    v_and_b32 v13, 0xffff0000, v10
    v_cvt_pk_bf16_f32 v48, v44, v44
    v_lshlrev_b32 v44, 16, v48
    v_mul_f32 v44, v44, v46
    v_cvt_pk_bf16_f32 v48, v44, v44
    v_lshlrev_b32 v44, 16, v48
    v_add_f32 v12, v12, v44
    v_cvt_pk_bf16_f32 v48, v12, v12
    v_lshlrev_b32 v12, 16, v48
    v_cvt_pk_bf16_f32 v48, v45, v45
    v_lshlrev_b32 v45, 16, v48
    v_mul_f32 v45, v45, v47
    v_cvt_pk_bf16_f32 v48, v45, v45
    v_lshlrev_b32 v45, 16, v48
    v_add_f32 v13, v13, v45
    v_cvt_pk_bf16_f32 v48, v13, v13
    v_lshlrev_b32 v13, 16, v48
    v_lshlrev_b32 v20, 3, v0
    s_mov_b32 s92, 12288
    s_mov_b32 s93, 16384
    buffer_load_dwordx2 v[22:23], v20, s[20:23], s92 offen
    buffer_load_dwordx2 v[24:25], v20, s[20:23], s93 offen
    v_add_f32 v26, v12, v13
    ds_swizzle_b32 v30, v26 offset:0x41f
    s_waitcnt lgkmcnt(0)
    v_add_f32 v26, v26, v30
    ds_swizzle_b32 v30, v26 offset:0x81f
    s_waitcnt lgkmcnt(0)
    v_add_f32 v26, v26, v30
    ds_swizzle_b32 v30, v26 offset:0x101f
    s_waitcnt lgkmcnt(0)
    v_add_f32 v26, v26, v30
    ds_swizzle_b32 v30, v26 offset:0x201f
    s_waitcnt lgkmcnt(0)
    v_add_f32 v26, v26, v30
    ds_swizzle_b32 v30, v26 offset:0x401f
    s_waitcnt lgkmcnt(0)
    v_add_f32 v26, v26, v30
    v_mov_b32 v30, v26
    s_nop 1
    v_permlane32_swap_b32 v30, v26
    s_nop 1
    v_add_f32 v26, v26, v30
    v_lshrrev_b32 v30, 6, v0
    v_lshlrev_b32 v30, 2, v30
    ds_write_b32 v30, v26 offset:4096
    s_waitcnt lgkmcnt(0)
    s_barrier
    v_mov_b32 v30, 0
    ds_read_b128 v[32:35], v30 offset:4096
    ds_read_b128 v[36:39], v30 offset:4112
    s_waitcnt lgkmcnt(0)
    v_add_f32 v26, v32, v33
    v_add_f32 v26, v26, v34
    v_add_f32 v26, v26, v35
    v_add_f32 v26, v26, v36
    v_add_f32 v26, v26, v37
    v_add_f32 v26, v26, v38
    v_add_f32 v26, v26, v39
    s_barrier
    v_mul_f32 v26, 0x3a800000, v26
    v_sub_f32 v27, v12, v26
    v_sub_f32 v28, v13, v26
    v_mul_f32 v27, v27, v27
    v_fmac_f32 v27, v28, v28
    ds_swizzle_b32 v30, v27 offset:0x41f
    s_waitcnt lgkmcnt(0)
    v_add_f32 v27, v27, v30
    ds_swizzle_b32 v30, v27 offset:0x81f
    s_waitcnt lgkmcnt(0)
    v_add_f32 v27, v27, v30
    ds_swizzle_b32 v30, v27 offset:0x101f
    s_waitcnt lgkmcnt(0)
    v_add_f32 v27, v27, v30
    ds_swizzle_b32 v30, v27 offset:0x201f
    s_waitcnt lgkmcnt(0)
    v_add_f32 v27, v27, v30
    ds_swizzle_b32 v30, v27 offset:0x401f
    s_waitcnt lgkmcnt(0)
    v_add_f32 v27, v27, v30
    v_mov_b32 v30, v27
    s_nop 1
    v_permlane32_swap_b32 v30, v27
    s_nop 1
    v_add_f32 v27, v27, v30
    v_lshrrev_b32 v30, 6, v0
    v_lshlrev_b32 v30, 2, v30
    ds_write_b32 v30, v27 offset:4096
    s_waitcnt lgkmcnt(0)
    s_barrier
    v_mov_b32 v30, 0
    ds_read_b128 v[32:35], v30 offset:4096
    ds_read_b128 v[36:39], v30 offset:4112
    s_waitcnt lgkmcnt(0)
    v_add_f32 v27, v32, v33
    v_add_f32 v27, v27, v34
    v_add_f32 v27, v27, v35
    v_add_f32 v27, v27, v36
    v_add_f32 v27, v27, v37
    v_add_f32 v27, v27, v38
    v_add_f32 v27, v27, v39
    s_barrier
    v_mul_f32 v27, 0x3a800000, v27
    v_cvt_pk_bf16_f32 v30, v27, v27
    v_lshlrev_b32 v27, 16, v30
    v_cvt_pk_bf16_f32 v30, v26, v26
    v_lshlrev_b32 v26, 16, v30
    v_add_f32 v27, 0x3727c5ac, v27
    v_cvt_pk_bf16_f32 v30, v27, v27
    v_lshlrev_b32 v27, 16, v30
    v_sqrt_f32 v27, v27
    s_nop 0
    v_cvt_pk_bf16_f32 v30, v27, v27
    v_lshlrev_b32 v27, 16, v30
    v_rcp_f32 v27, v27
    s_waitcnt vmcnt(0)
    v_sub_f32 v28, v12, v26
    v_cvt_pk_bf16_f32 v30, v28, v28
    v_lshlrev_b32 v28, 16, v30
    v_mul_f32 v28, v28, v27
    v_cvt_pk_bf16_f32 v30, v28, v28
    v_lshlrev_b32 v28, 16, v30
    v_add_f32 v29, 1.0, v24
    v_cvt_pk_bf16_f32 v30, v29, v29
    v_lshlrev_b32 v29, 16, v30
    v_mul_f32 v28, v28, v29
    v_cvt_pk_bf16_f32 v30, v28, v28
    v_lshlrev_b32 v28, 16, v30
    v_add_f32 v40, v28, v22
    v_cvt_pk_bf16_f32 v30, v40, v40
    v_lshlrev_b32 v40, 16, v30
    v_sub_f32 v28, v13, v26
    v_cvt_pk_bf16_f32 v30, v28, v28
    v_lshlrev_b32 v28, 16, v30
    v_mul_f32 v28, v28, v27
    v_cvt_pk_bf16_f32 v30, v28, v28
    v_lshlrev_b32 v28, 16, v30
    v_add_f32 v29, 1.0, v25
    v_cvt_pk_bf16_f32 v30, v29, v29
    v_lshlrev_b32 v29, 16, v30
    v_mul_f32 v28, v28, v29
    v_cvt_pk_bf16_f32 v30, v28, v28
    v_lshlrev_b32 v28, 16, v30
    v_add_f32 v41, v28, v23
    v_cvt_pk_bf16_f32 v30, v41, v41
    v_lshlrev_b32 v41, 16, v30
    v_lshlrev_b32 v20, 3, v0
    ds_write_b64 v20, v[40:41] offset:0
    s_waitcnt lgkmcnt(0)
    s_barrier
    v_lshlrev_b32 v7, 2, v4
    ds_read_b32 v16, v7 offset:0
    ds_read_b32 v17, v7 offset:256
    ds_read_b32 v18, v7 offset:512
    ds_read_b32 v19, v7 offset:768
    v_mov_b32 v32, 0
    v_mov_b32 v33, 0
    v_mov_b32 v34, 0
    v_mov_b32 v35, 0
    v_mov_b32 v36, 0
    v_mov_b32 v37, 0
    v_mov_b32 v38, 0
    v_mov_b32 v39, 0
    v_mov_b32 v40, 0
    v_mov_b32 v41, 0
    v_mov_b32 v42, 0
    v_mov_b32 v43, 0
    v_mov_b32 v44, 0
    v_mov_b32 v45, 0
    v_mov_b32 v46, 0
    v_mov_b32 v47, 0
    s_waitcnt vmcnt(0) lgkmcnt(0)
    v_lshlrev_b32 v8, 16, v64
    v_and_b32 v9, 0xffff0000, v64
    v_fmac_f32 v32, v16, v8
    v_fmac_f32 v33, v16, v9
    v_lshlrev_b32 v8, 16, v65
    v_and_b32 v9, 0xffff0000, v65
    v_fmac_f32 v34, v16, v8
    v_fmac_f32 v35, v16, v9
    v_lshlrev_b32 v8, 16, v66
    v_and_b32 v9, 0xffff0000, v66
    v_fmac_f32 v36, v16, v8
    v_fmac_f32 v37, v16, v9
    v_lshlrev_b32 v8, 16, v67
    v_and_b32 v9, 0xffff0000, v67
    v_fmac_f32 v38, v16, v8
    v_fmac_f32 v39, v16, v9
    v_lshlrev_b32 v8, 16, v68
    v_and_b32 v9, 0xffff0000, v68
    v_fmac_f32 v32, v17, v8
    v_fmac_f32 v33, v17, v9
    v_lshlrev_b32 v8, 16, v69
    v_and_b32 v9, 0xffff0000, v69
    v_fmac_f32 v34, v17, v8
    v_fmac_f32 v35, v17, v9
    v_lshlrev_b32 v8, 16, v70
    v_and_b32 v9, 0xffff0000, v70
    v_fmac_f32 v36, v17, v8
    v_fmac_f32 v37, v17, v9
    v_lshlrev_b32 v8, 16, v71
    v_and_b32 v9, 0xffff0000, v71
    v_fmac_f32 v38, v17, v8
    v_fmac_f32 v39, v17, v9
    v_lshlrev_b32 v8, 16, v72
    v_and_b32 v9, 0xffff0000, v72
    v_fmac_f32 v32, v18, v8
    v_fmac_f32 v33, v18, v9
    v_lshlrev_b32 v8, 16, v73
    v_and_b32 v9, 0xffff0000, v73
    v_fmac_f32 v34, v18, v8
    v_fmac_f32 v35, v18, v9
    v_lshlrev_b32 v8, 16, v74
    v_and_b32 v9, 0xffff0000, v74
    v_fmac_f32 v36, v18, v8
    v_fmac_f32 v37, v18, v9
    v_lshlrev_b32 v8, 16, v75
    v_and_b32 v9, 0xffff0000, v75
    v_fmac_f32 v38, v18, v8
    v_fmac_f32 v39, v18, v9
    v_lshlrev_b32 v8, 16, v76
    v_and_b32 v9, 0xffff0000, v76
    v_fmac_f32 v32, v19, v8
    v_fmac_f32 v33, v19, v9
    v_lshlrev_b32 v8, 16, v77
    v_and_b32 v9, 0xffff0000, v77
    v_fmac_f32 v34, v19, v8
    v_fmac_f32 v35, v19, v9
    v_lshlrev_b32 v8, 16, v78
    v_and_b32 v9, 0xffff0000, v78
    v_fmac_f32 v36, v19, v8
    v_fmac_f32 v37, v19, v9
    v_lshlrev_b32 v8, 16, v79
    v_and_b32 v9, 0xffff0000, v79
    v_fmac_f32 v38, v19, v8
    v_fmac_f32 v39, v19, v9
    v_lshlrev_b32 v8, 16, v80
    v_and_b32 v9, 0xffff0000, v80
    v_fmac_f32 v40, v16, v8
    v_fmac_f32 v41, v16, v9
    v_lshlrev_b32 v8, 16, v81
    v_and_b32 v9, 0xffff0000, v81
    v_fmac_f32 v42, v16, v8
    v_fmac_f32 v43, v16, v9
    v_lshlrev_b32 v8, 16, v82
    v_and_b32 v9, 0xffff0000, v82
    v_fmac_f32 v44, v16, v8
    v_fmac_f32 v45, v16, v9
    v_lshlrev_b32 v8, 16, v83
    v_and_b32 v9, 0xffff0000, v83
    v_fmac_f32 v46, v16, v8
    v_fmac_f32 v47, v16, v9
    v_lshlrev_b32 v8, 16, v84
    v_and_b32 v9, 0xffff0000, v84
    v_fmac_f32 v40, v17, v8
    v_fmac_f32 v41, v17, v9
    v_lshlrev_b32 v8, 16, v85
    v_and_b32 v9, 0xffff0000, v85
    v_fmac_f32 v42, v17, v8
    v_fmac_f32 v43, v17, v9
    v_lshlrev_b32 v8, 16, v86
    v_and_b32 v9, 0xffff0000, v86
    v_fmac_f32 v44, v17, v8
    v_fmac_f32 v45, v17, v9
    v_lshlrev_b32 v8, 16, v87
    v_and_b32 v9, 0xffff0000, v87
    v_fmac_f32 v46, v17, v8
    v_fmac_f32 v47, v17, v9
    v_lshlrev_b32 v8, 16, v88
    v_and_b32 v9, 0xffff0000, v88
    v_fmac_f32 v40, v18, v8
    v_fmac_f32 v41, v18, v9
    v_lshlrev_b32 v8, 16, v89
    v_and_b32 v9, 0xffff0000, v89
    v_fmac_f32 v42, v18, v8
    v_fmac_f32 v43, v18, v9
    v_lshlrev_b32 v8, 16, v90
    v_and_b32 v9, 0xffff0000, v90
    v_fmac_f32 v44, v18, v8
    v_fmac_f32 v45, v18, v9
    v_lshlrev_b32 v8, 16, v91
    v_and_b32 v9, 0xffff0000, v91
    v_fmac_f32 v46, v18, v8
    v_fmac_f32 v47, v18, v9
    v_lshlrev_b32 v8, 16, v92
    v_and_b32 v9, 0xffff0000, v92
    v_fmac_f32 v40, v19, v8
    v_fmac_f32 v41, v19, v9
    v_lshlrev_b32 v8, 16, v93
    v_and_b32 v9, 0xffff0000, v93
    v_fmac_f32 v42, v19, v8
    v_fmac_f32 v43, v19, v9
    v_lshlrev_b32 v8, 16, v94
    v_and_b32 v9, 0xffff0000, v94
    v_fmac_f32 v44, v19, v8
    v_fmac_f32 v45, v19, v9
    v_lshlrev_b32 v8, 16, v95
    v_and_b32 v9, 0xffff0000, v95
    v_fmac_f32 v46, v19, v8
    v_fmac_f32 v47, v19, v9
    v_lshlrev_b32 v7, 5, v0
    ds_write_b128 v7, v[32:35] offset:8192
    ds_write_b128 v7, v[36:39] offset:8208
    ds_write_b128 v7, v[40:43] offset:24576
    ds_write_b128 v7, v[44:47] offset:24592
    s_waitcnt lgkmcnt(0)
    s_barrier
    v_and_b32 v10, 63, v0
    v_lshrrev_b32 v11, 6, v0
    v_mul_u32_u24 v12, 2048, v11
    v_lshl_add_u32 v12, v10, 2, v12
    ds_read_b32 v16, v12 offset:8192
    ds_read_b32 v17, v12 offset:8448
    ds_read_b32 v18, v12 offset:8704
    ds_read_b32 v19, v12 offset:8960
    ds_read_b32 v20, v12 offset:9216
    ds_read_b32 v21, v12 offset:9472
    ds_read_b32 v22, v12 offset:9728
    ds_read_b32 v23, v12 offset:9984
    s_waitcnt lgkmcnt(0)
    v_add_f32 v16, v16, v17
    v_add_f32 v16, v16, v18
    v_add_f32 v16, v16, v19
    v_add_f32 v16, v16, v20
    v_add_f32 v16, v16, v21
    v_add_f32 v16, v16, v22
    v_add_f32 v16, v16, v23
    v_mov_b32 v48, v16
    ds_read_b32 v16, v12 offset:24576
    ds_read_b32 v17, v12 offset:24832
    ds_read_b32 v18, v12 offset:25088
    ds_read_b32 v19, v12 offset:25344
    ds_read_b32 v20, v12 offset:25600
    ds_read_b32 v21, v12 offset:25856
    ds_read_b32 v22, v12 offset:26112
    ds_read_b32 v23, v12 offset:26368
    s_waitcnt lgkmcnt(0)
    v_add_f32 v16, v16, v17
    v_add_f32 v16, v16, v18
    v_add_f32 v16, v16, v19
    v_add_f32 v16, v16, v20
    v_add_f32 v16, v16, v21
    v_add_f32 v16, v16, v22
    v_add_f32 v16, v16, v23
    v_mov_b32 v49, v16
    s_barrier
    v_lshlrev_b32 v12, 2, v0
    ds_write_b32 v12, v48 offset:8192
    ds_write_b32 v12, v49 offset:24576
    s_waitcnt lgkmcnt(0)
    s_barrier
    v_lshlrev_b32 v12, 2, v10
    ds_read_b32 v16, v12 offset:8192
    ds_read_b32 v17, v12 offset:8448
    ds_read_b32 v18, v12 offset:8704
    ds_read_b32 v19, v12 offset:8960
    ds_read_b32 v20, v12 offset:9216
    ds_read_b32 v21, v12 offset:9472
    ds_read_b32 v22, v12 offset:9728
    ds_read_b32 v23, v12 offset:9984
    s_waitcnt lgkmcnt(0)
    v_add_f32 v16, v16, v17
    v_add_f32 v16, v16, v18
    v_add_f32 v16, v16, v19
    v_add_f32 v16, v16, v20
    v_add_f32 v16, v16, v21
    v_add_f32 v16, v16, v22
    v_add_f32 v16, v16, v23
    v_mov_b32 v50, v16
    ds_read_b32 v16, v12 offset:24576
    ds_read_b32 v17, v12 offset:24832
    ds_read_b32 v18, v12 offset:25088
    ds_read_b32 v19, v12 offset:25344
    ds_read_b32 v20, v12 offset:25600
    ds_read_b32 v21, v12 offset:25856
    ds_read_b32 v22, v12 offset:26112
    ds_read_b32 v23, v12 offset:26368
    s_waitcnt lgkmcnt(0)
    v_add_f32 v16, v16, v17
    v_add_f32 v16, v16, v18
    v_add_f32 v16, v16, v19
    v_add_f32 v16, v16, v20
    v_add_f32 v16, v16, v21
    v_add_f32 v16, v16, v22
    v_add_f32 v16, v16, v23
    v_mov_b32 v51, v16
    v_cmp_gt_u32 vcc, 64, v0
    s_and_saveexec_b64 s[34:35], vcc
    v_lshlrev_b32 v11, 2, v0
    s_mul_i32 s31, s29, 28672
    s_lshl_b32 s30, s30, 8
    s_add_u32 s31, s31, s30
    s_add_u32 s31, s31, 65536
    buffer_store_dword v50, v11, s[20:23], s31 offen
    s_add_u32 s31, s31, 14336
    buffer_store_dword v51, v11, s[20:23], s31 offen
k5_gu_kernel_end:
    s_endpgm
.p2align 8
.globl k6_down_kernel
.type k6_down_kernel,@function
k6_down_kernel:
    s_cmp_ge_u32 s2, 256
    s_cbranch_scc1 k6_down_kernel_end
    s_load_dwordx2 s[6:7], s[0:1], 64
    s_load_dwordx2 s[8:9], s[0:1], 104
    s_waitcnt lgkmcnt(0)
    s_mov_b32 s16, s6
    s_mov_b32 s17, s7
    s_mov_b32 s18, 7340032
    s_mov_b32 s19, 0x00020000
    s_mov_b32 s20, s8
    s_mov_b32 s21, s9
    s_mov_b32 s22, 268435456
    s_mov_b32 s23, 0x00020000
    s_and_b32 s26, s2, 15
    s_lshr_b32 s27, s2, 4
    s_lshl_b32 s24, s26, 7
    s_mul_i32 s25, s27, 224
    v_and_b32 v2, 7, v0
    v_lshrrev_b32 v3, 3, v0
    v_add_u32 v4, s25, v3
    s_mov_b32 s90, 2048
    v_mul_lo_u32 v5, v4, s90
    v_lshlrev_b32 v6, 4, v2
    v_add3_u32 v5, v5, v6, s24
    s_mov_b32 s91, 0
    buffer_load_dwordx4 v[64:67], v5, s[16:19], s91 offen
    s_mov_b32 s91, 131072
    buffer_load_dwordx4 v[68:71], v5, s[16:19], s91 offen
    s_mov_b32 s91, 262144
    buffer_load_dwordx4 v[72:75], v5, s[16:19], s91 offen
    s_mov_b32 s91, 393216
    buffer_load_dwordx4 v[76:79], v5, s[16:19], s91 offen
    v_add_u32 v8, s25, v0
    v_lshlrev_b32 v8, 2, v8
    s_mov_b32 s92, 65536
    buffer_load_dword v16, v8, s[20:23], s92 offen
    s_mov_b32 s92, 79872
    buffer_load_dword v20, v8, s[20:23], s92 offen
    s_mov_b32 s92, 94208
    buffer_load_dword v17, v8, s[20:23], s92 offen
    s_mov_b32 s92, 108544
    buffer_load_dword v21, v8, s[20:23], s92 offen
    s_mov_b32 s92, 122880
    buffer_load_dword v18, v8, s[20:23], s92 offen
    s_mov_b32 s92, 137216
    buffer_load_dword v22, v8, s[20:23], s92 offen
    s_mov_b32 s92, 151552
    buffer_load_dword v19, v8, s[20:23], s92 offen
    s_mov_b32 s92, 165888
    buffer_load_dword v23, v8, s[20:23], s92 offen
    s_waitcnt vmcnt(0)
    v_add_f32 v16, v16, v17
    v_add_f32 v18, v18, v19
    v_add_f32 v16, v16, v18
    v_add_f32 v20, v20, v21
    v_add_f32 v22, v22, v23
    v_add_f32 v20, v20, v22
    v_cvt_pk_bf16_f32 v24, v16, v16
    v_lshlrev_b32 v16, 16, v24
    v_cvt_pk_bf16_f32 v24, v20, v20
    v_lshlrev_b32 v20, 16, v24
    v_mul_f32 v24, v16, v16
    v_mul_f32 v24, v24, v16
    v_mul_f32 v24, 0x3d372713, v24
    v_add_f32 v24, v24, v16
    v_mul_f32 v24, 0x3f4c422a, v24
    v_mul_f32 v25, 0x4038aa3b, v24
    v_exp_f32 v25, v25
    s_nop 0
    v_add_f32 v25, 1.0, v25
    v_rcp_f32 v25, v25
    s_nop 0
    v_fma_f32 v25, v25, -2.0, 1.0
    v_add_f32 v25, 1.0, v25
    v_mul_f32 v25, 0.5, v25
    v_mul_f32 v25, v25, v16
    v_cvt_pk_bf16_f32 v24, v25, v25
    v_lshlrev_b32 v25, 16, v24
    v_mul_f32 v25, v25, v20
    v_cvt_pk_bf16_f32 v24, v25, v25
    v_lshlrev_b32 v25, 16, v24
    v_cmp_gt_u32 vcc, 224, v0
    v_cndmask_b32 v25, 0, v25, vcc
    v_lshlrev_b32 v8, 2, v0
    ds_write_b32 v8, v25
    s_waitcnt lgkmcnt(0)
    s_barrier
    v_subrev_u32 v4, s25, v4
    v_lshlrev_b32 v7, 2, v4
    ds_read_b32 v16, v7 offset:0
    ds_read_b32 v17, v7 offset:256
    ds_read_b32 v18, v7 offset:512
    ds_read_b32 v19, v7 offset:768
    v_mov_b32 v32, 0
    v_mov_b32 v33, 0
    v_mov_b32 v34, 0
    v_mov_b32 v35, 0
    v_mov_b32 v36, 0
    v_mov_b32 v37, 0
    v_mov_b32 v38, 0
    v_mov_b32 v39, 0
    s_waitcnt vmcnt(0) lgkmcnt(0)
    v_lshlrev_b32 v8, 16, v64
    v_and_b32 v9, 0xffff0000, v64
    v_fmac_f32 v32, v16, v8
    v_fmac_f32 v33, v16, v9
    v_lshlrev_b32 v8, 16, v65
    v_and_b32 v9, 0xffff0000, v65
    v_fmac_f32 v34, v16, v8
    v_fmac_f32 v35, v16, v9
    v_lshlrev_b32 v8, 16, v66
    v_and_b32 v9, 0xffff0000, v66
    v_fmac_f32 v36, v16, v8
    v_fmac_f32 v37, v16, v9
    v_lshlrev_b32 v8, 16, v67
    v_and_b32 v9, 0xffff0000, v67
    v_fmac_f32 v38, v16, v8
    v_fmac_f32 v39, v16, v9
    v_lshlrev_b32 v8, 16, v68
    v_and_b32 v9, 0xffff0000, v68
    v_fmac_f32 v32, v17, v8
    v_fmac_f32 v33, v17, v9
    v_lshlrev_b32 v8, 16, v69
    v_and_b32 v9, 0xffff0000, v69
    v_fmac_f32 v34, v17, v8
    v_fmac_f32 v35, v17, v9
    v_lshlrev_b32 v8, 16, v70
    v_and_b32 v9, 0xffff0000, v70
    v_fmac_f32 v36, v17, v8
    v_fmac_f32 v37, v17, v9
    v_lshlrev_b32 v8, 16, v71
    v_and_b32 v9, 0xffff0000, v71
    v_fmac_f32 v38, v17, v8
    v_fmac_f32 v39, v17, v9
    v_lshlrev_b32 v8, 16, v72
    v_and_b32 v9, 0xffff0000, v72
    v_fmac_f32 v32, v18, v8
    v_fmac_f32 v33, v18, v9
    v_lshlrev_b32 v8, 16, v73
    v_and_b32 v9, 0xffff0000, v73
    v_fmac_f32 v34, v18, v8
    v_fmac_f32 v35, v18, v9
    v_lshlrev_b32 v8, 16, v74
    v_and_b32 v9, 0xffff0000, v74
    v_fmac_f32 v36, v18, v8
    v_fmac_f32 v37, v18, v9
    v_lshlrev_b32 v8, 16, v75
    v_and_b32 v9, 0xffff0000, v75
    v_fmac_f32 v38, v18, v8
    v_fmac_f32 v39, v18, v9
    v_lshlrev_b32 v8, 16, v76
    v_and_b32 v9, 0xffff0000, v76
    v_fmac_f32 v32, v19, v8
    v_fmac_f32 v33, v19, v9
    v_lshlrev_b32 v8, 16, v77
    v_and_b32 v9, 0xffff0000, v77
    v_fmac_f32 v34, v19, v8
    v_fmac_f32 v35, v19, v9
    v_lshlrev_b32 v8, 16, v78
    v_and_b32 v9, 0xffff0000, v78
    v_fmac_f32 v36, v19, v8
    v_fmac_f32 v37, v19, v9
    v_lshlrev_b32 v8, 16, v79
    v_and_b32 v9, 0xffff0000, v79
    v_fmac_f32 v38, v19, v8
    v_fmac_f32 v39, v19, v9
    v_lshlrev_b32 v7, 5, v0
    ds_write_b128 v7, v[32:35] offset:8192
    ds_write_b128 v7, v[36:39] offset:8208
    s_waitcnt lgkmcnt(0)
    s_barrier
    v_and_b32 v10, 63, v0
    v_lshrrev_b32 v11, 6, v0
    v_mul_u32_u24 v12, 2048, v11
    v_lshl_add_u32 v12, v10, 2, v12
    ds_read_b32 v16, v12 offset:8192
    ds_read_b32 v17, v12 offset:8448
    ds_read_b32 v18, v12 offset:8704
    ds_read_b32 v19, v12 offset:8960
    ds_read_b32 v20, v12 offset:9216
    ds_read_b32 v21, v12 offset:9472
    ds_read_b32 v22, v12 offset:9728
    ds_read_b32 v23, v12 offset:9984
    s_waitcnt lgkmcnt(0)
    v_add_f32 v16, v16, v17
    v_add_f32 v16, v16, v18
    v_add_f32 v16, v16, v19
    v_add_f32 v16, v16, v20
    v_add_f32 v16, v16, v21
    v_add_f32 v16, v16, v22
    v_add_f32 v16, v16, v23
    v_mov_b32 v48, v16
    s_barrier
    v_lshlrev_b32 v12, 2, v0
    ds_write_b32 v12, v48 offset:8192
    s_waitcnt lgkmcnt(0)
    s_barrier
    v_lshlrev_b32 v12, 2, v10
    ds_read_b32 v16, v12 offset:8192
    ds_read_b32 v17, v12 offset:8448
    ds_read_b32 v18, v12 offset:8704
    ds_read_b32 v19, v12 offset:8960
    ds_read_b32 v20, v12 offset:9216
    ds_read_b32 v21, v12 offset:9472
    ds_read_b32 v22, v12 offset:9728
    ds_read_b32 v23, v12 offset:9984
    s_waitcnt lgkmcnt(0)
    v_add_f32 v16, v16, v17
    v_add_f32 v16, v16, v18
    v_add_f32 v16, v16, v19
    v_add_f32 v16, v16, v20
    v_add_f32 v16, v16, v21
    v_add_f32 v16, v16, v22
    v_add_f32 v16, v16, v23
    v_mov_b32 v50, v16
    v_cmp_gt_u32 vcc, 64, v0
    s_and_saveexec_b64 s[34:35], vcc
    v_lshlrev_b32 v11, 2, v0
    s_lshl_b32 s28, s27, 12
    s_lshl_b32 s29, s26, 8
    s_add_u32 s28, s28, s29
    s_add_u32 s28, s28, 196608
    buffer_store_dword v50, v11, s[20:23], s28 offen
k6_down_kernel_end:
    s_endpgm
.p2align 8
.globl k7_out_kernel
.type k7_out_kernel,@function
k7_out_kernel:
    s_cmp_ge_u32 s2, 1
    s_cbranch_scc1 k7_out_kernel_end
    s_load_dwordx2 s[4:5], s[0:1], 0
    s_load_dwordx2 s[6:7], s[0:1], 88
    s_load_dwordx2 s[8:9], s[0:1], 104
    s_waitcnt lgkmcnt(0)
    s_mov_b32 s12, s4
    s_mov_b32 s13, s5
    s_mov_b32 s14, 2048
    s_mov_b32 s15, 0x00020000
    s_mov_b32 s16, s6
    s_mov_b32 s17, s7
    s_mov_b32 s18, 2048
    s_mov_b32 s19, 0x00020000
    s_mov_b32 s20, s8
    s_mov_b32 s21, s9
    s_mov_b32 s22, 268435456
    s_mov_b32 s23, 0x00020000
    v_lshlrev_b32 v1, 2, v0
    buffer_load_dword v10, v1, s[12:15], 0 offen
    v_lshlrev_b32 v20, 3, v0
    s_mov_b32 s92, 196608
    buffer_load_dwordx2 v[64:65], v20, s[20:23], s92 offen
    s_mov_b32 s92, 200704
    buffer_load_dwordx2 v[66:67], v20, s[20:23], s92 offen
    s_mov_b32 s92, 204800
    buffer_load_dwordx2 v[68:69], v20, s[20:23], s92 offen
    s_mov_b32 s92, 208896
    buffer_load_dwordx2 v[70:71], v20, s[20:23], s92 offen
    s_mov_b32 s92, 212992
    buffer_load_dwordx2 v[72:73], v20, s[20:23], s92 offen
    s_mov_b32 s92, 217088
    buffer_load_dwordx2 v[74:75], v20, s[20:23], s92 offen
    s_mov_b32 s92, 221184
    buffer_load_dwordx2 v[76:77], v20, s[20:23], s92 offen
    s_mov_b32 s92, 225280
    buffer_load_dwordx2 v[78:79], v20, s[20:23], s92 offen
    s_mov_b32 s92, 229376
    buffer_load_dwordx2 v[80:81], v20, s[20:23], s92 offen
    s_mov_b32 s92, 233472
    buffer_load_dwordx2 v[82:83], v20, s[20:23], s92 offen
    s_mov_b32 s92, 237568
    buffer_load_dwordx2 v[84:85], v20, s[20:23], s92 offen
    s_mov_b32 s92, 241664
    buffer_load_dwordx2 v[86:87], v20, s[20:23], s92 offen
    s_mov_b32 s92, 245760
    buffer_load_dwordx2 v[88:89], v20, s[20:23], s92 offen
    s_mov_b32 s92, 249856
    buffer_load_dwordx2 v[90:91], v20, s[20:23], s92 offen
    s_mov_b32 s92, 253952
    buffer_load_dwordx2 v[92:93], v20, s[20:23], s92 offen
    s_mov_b32 s92, 258048
    buffer_load_dwordx2 v[94:95], v20, s[20:23], s92 offen
    s_mov_b32 s92, 20480
    buffer_load_dwordx2 v[60:61], v20, s[20:23], s92 offen
    v_lshlrev_b32 v20, 3, v0
    s_mov_b32 s93, 49152
    buffer_load_dwordx2 v[44:45], v20, s[20:23], s93 offen
    s_mov_b32 s92, 8192
    buffer_load_dwordx2 v[46:47], v20, s[20:23], s92 offen
    s_waitcnt vmcnt(0)
    v_lshlrev_b32 v12, 16, v10
    v_and_b32 v13, 0xffff0000, v10
    v_cvt_pk_bf16_f32 v48, v44, v44
    v_lshlrev_b32 v44, 16, v48
    v_mul_f32 v44, v44, v46
    v_cvt_pk_bf16_f32 v48, v44, v44
    v_lshlrev_b32 v44, 16, v48
    v_add_f32 v12, v12, v44
    v_cvt_pk_bf16_f32 v48, v12, v12
    v_lshlrev_b32 v12, 16, v48
    v_cvt_pk_bf16_f32 v48, v45, v45
    v_lshlrev_b32 v45, 16, v48
    v_mul_f32 v45, v45, v47
    v_cvt_pk_bf16_f32 v48, v45, v45
    v_lshlrev_b32 v45, 16, v48
    v_add_f32 v13, v13, v45
    v_cvt_pk_bf16_f32 v48, v13, v13
    v_lshlrev_b32 v13, 16, v48
    v_add_f32 v64, v64, v66
    v_add_f32 v64, v64, v68
    v_add_f32 v64, v64, v70
    v_add_f32 v64, v64, v72
    v_add_f32 v64, v64, v74
    v_add_f32 v64, v64, v76
    v_add_f32 v64, v64, v78
    v_add_f32 v64, v64, v80
    v_add_f32 v64, v64, v82
    v_add_f32 v64, v64, v84
    v_add_f32 v64, v64, v86
    v_add_f32 v64, v64, v88
    v_add_f32 v64, v64, v90
    v_add_f32 v64, v64, v92
    v_add_f32 v64, v64, v94
    v_cvt_pk_bf16_f32 v50, v64, v64
    v_lshlrev_b32 v64, 16, v50
    v_mul_f32 v64, v64, v60
    v_cvt_pk_bf16_f32 v50, v64, v64
    v_lshlrev_b32 v64, 16, v50
    v_add_f32 v64, v64, v12
    v_add_f32 v65, v65, v67
    v_add_f32 v65, v65, v69
    v_add_f32 v65, v65, v71
    v_add_f32 v65, v65, v73
    v_add_f32 v65, v65, v75
    v_add_f32 v65, v65, v77
    v_add_f32 v65, v65, v79
    v_add_f32 v65, v65, v81
    v_add_f32 v65, v65, v83
    v_add_f32 v65, v65, v85
    v_add_f32 v65, v65, v87
    v_add_f32 v65, v65, v89
    v_add_f32 v65, v65, v91
    v_add_f32 v65, v65, v93
    v_add_f32 v65, v65, v95
    v_cvt_pk_bf16_f32 v50, v65, v65
    v_lshlrev_b32 v65, 16, v50
    v_mul_f32 v65, v65, v61
    v_cvt_pk_bf16_f32 v50, v65, v65
    v_lshlrev_b32 v65, 16, v50
    v_add_f32 v65, v65, v13
    v_cvt_pk_bf16_f32 v50, v64, v65
    buffer_store_dword v50, v1, s[16:19], 0 offen
k7_out_kernel_end:
    s_endpgm
.section .rodata,"a"
.p2align 6
.amdhsa_kernel k1_mod_kernel
  .amdhsa_next_free_vgpr 128
  .amdhsa_next_free_sgpr 102
  .amdhsa_accum_offset 128
  .amdhsa_group_segment_fixed_size 0
  .amdhsa_kernarg_size 112
  .amdhsa_user_sgpr_count 2
  .amdhsa_user_sgpr_kernarg_segment_ptr 1
  .amdhsa_system_sgpr_workgroup_id_x 1
.end_amdhsa_kernel
.p2align 6
.amdhsa_kernel k2_q_kernel
  .amdhsa_next_free_vgpr 128
  .amdhsa_next_free_sgpr 102
  .amdhsa_accum_offset 128
  .amdhsa_group_segment_fixed_size 0
  .amdhsa_kernarg_size 112
  .amdhsa_user_sgpr_count 2
  .amdhsa_user_sgpr_kernarg_segment_ptr 1
  .amdhsa_system_sgpr_workgroup_id_x 1
.end_amdhsa_kernel
.p2align 6
.amdhsa_kernel k3_attn_kernel
  .amdhsa_next_free_vgpr 256
  .amdhsa_next_free_sgpr 102
  .amdhsa_accum_offset 256
  .amdhsa_group_segment_fixed_size 0
  .amdhsa_kernarg_size 112
  .amdhsa_user_sgpr_count 2
  .amdhsa_user_sgpr_kernarg_segment_ptr 1
  .amdhsa_system_sgpr_workgroup_id_x 1
.end_amdhsa_kernel
.p2align 6
.amdhsa_kernel k4_wo_kernel
  .amdhsa_next_free_vgpr 128
  .amdhsa_next_free_sgpr 102
  .amdhsa_accum_offset 128
  .amdhsa_group_segment_fixed_size 0
  .amdhsa_kernarg_size 112
  .amdhsa_user_sgpr_count 2
  .amdhsa_user_sgpr_kernarg_segment_ptr 1
  .amdhsa_system_sgpr_workgroup_id_x 1
.end_amdhsa_kernel
.p2align 6
.amdhsa_kernel k5_gu_kernel
  .amdhsa_next_free_vgpr 128
  .amdhsa_next_free_sgpr 102
  .amdhsa_accum_offset 128
  .amdhsa_group_segment_fixed_size 0
  .amdhsa_kernarg_size 112
  .amdhsa_user_sgpr_count 2
  .amdhsa_user_sgpr_kernarg_segment_ptr 1
  .amdhsa_system_sgpr_workgroup_id_x 1
.end_amdhsa_kernel
.p2align 6
.amdhsa_kernel k6_down_kernel
  .amdhsa_next_free_vgpr 128
  .amdhsa_next_free_sgpr 102
  .amdhsa_accum_offset 128
  .amdhsa_group_segment_fixed_size 0
  .amdhsa_kernarg_size 112
  .amdhsa_user_sgpr_count 2
  .amdhsa_user_sgpr_kernarg_segment_ptr 1
  .amdhsa_system_sgpr_workgroup_id_x 1
.end_amdhsa_kernel
.p2align 6
.amdhsa_kernel k7_out_kernel
  .amdhsa_next_free_vgpr 128
  .amdhsa_next_free_sgpr 102
  .amdhsa_accum_offset 128
  .amdhsa_group_segment_fixed_size 0
  .amdhsa_kernarg_size 112
  .amdhsa_user_sgpr_count 2
  .amdhsa_user_sgpr_kernarg_segment_ptr 1
  .amdhsa_system_sgpr_workgroup_id_x 1
.end_amdhsa_kernel
```
